```python
import torch

def _softmax(x, axis=-1):
    return torch.softmax(x, dim=axis)
def _gelu(x):
    return torch.nn.functional.gelu(x, approximate="tanh")
def _silu(x):
    return torch.nn.functional.silu(x)
def _sigmoid(x):
    return torch.sigmoid(x)
def _layernorm(x, axis=-1, eps=1e-5):
    m = x.mean(dim=axis, keepdim=True)
    v = x.var(dim=axis, keepdim=True, unbiased=False)
    return (x - m) / torch.sqrt(v + eps)
def _scatter_add(tgt, idx, src, axis=0):
    return tgt.clone().index_add_(axis, idx, src)
def _segment_sum(src, seg, n):
    out = torch.zeros((n,) + src.shape[1:], dtype=src.dtype)
    return out.index_add_(0, seg, src)
def _pad(x, pw):
    flat = tuple(v for pair in reversed(pw) for v in pair)
    return torch.nn.functional.pad(x, flat)

kernel_name = 'sequential_preLN__ssm_conv_h3__swiglu_ffn__prompt'

def setup_inputs():

    _w = (lambda a: (lambda t: t.to(torch.bfloat16) if t.is_floating_point() else t)(torch.as_tensor(a)))
    def _A_setup():
        B, S, D = 1, 2048, 640
        ks = 4
        return {
            "q": _w((lambda *s: torch.randn(*s, dtype=torch.bfloat16) * 0.05)(B, S, D)),
            "k": _w((lambda *s: torch.randn(*s, dtype=torch.bfloat16) * 0.4)(B, S, D)),
            "v": _w((lambda *s: torch.randn(*s, dtype=torch.bfloat16) * 0.4)(B, S, D)),
            "shift_k": _w((lambda *s: torch.randn(*s, dtype=torch.bfloat16) * 0.4)(D, ks) * 0.5),
            "ssm_k": _w((lambda *s: torch.randn(*s, dtype=torch.bfloat16) * 0.4)(D, S) * (1.0 / S ** 0.5)),
            "ssm_D": _w((lambda *s: torch.randn(*s, dtype=torch.bfloat16) * 0.4)(D)),
        }
    _A_in = _A_setup()

    def _B_setup():
        B, S, D, F = 1, 2048, 640, 1728
        return {
            "x": _w((lambda *s: torch.randn(*s, dtype=torch.bfloat16) * 0.05)(B, S, D)),
            "w_gate": _w((lambda *s: torch.randn(*s, dtype=torch.bfloat16) * 0.05)(D, F)),
            "w_up": _w((lambda *s: torch.randn(*s, dtype=torch.bfloat16) * 0.05)(D, F)),
            "w_down": _w((lambda *s: torch.randn(*s, dtype=torch.bfloat16) * 0.05)(F, D)),
        }
    _B_in = _B_setup()

    return {
        "A_q": _A_in["q"],
        "A_k": _A_in["k"],
        "A_v": _A_in["v"],
        "A_shift_k": _A_in["shift_k"],
        "A_ssm_k": _A_in["ssm_k"],
        "A_ssm_D": _A_in["ssm_D"],
        "B_x": _B_in["x"],
        "B_w_gate": _B_in["w_gate"],
        "B_w_up": _B_in["w_up"],
        "B_w_down": _B_in["w_down"],
    }

def reference(A_q, A_k, A_v, A_shift_k, A_ssm_k, A_ssm_D, B_x, B_w_gate, B_w_up, B_w_down):
    def _A_ref(q, k, v, shift_k, ssm_k, ssm_D):
        B, S, D = q.shape
        ks = shift_k.shape[-1]
        k_pad = _pad(k, ((0, 0), (ks - 1, 0), (0, 0)))
        k_shift = torch.zeros_like(k)
        for t in range(ks):
            k_shift = k_shift + k_pad[:, t:t + S, :] * shift_k[:, ks - 1 - t][None, None, :]
        kv = k_shift * v
        L = 2 * S
        kv_pad = _pad(kv, ((0, 0), (0, S), (0, 0)))
        kf_pad = _pad(ssm_k, ((0, 0), (0, S)))
        kv_f = (lambda x, axes=(-2,-1): torch.fft.rfft2(x.float(), dim=axes))(kv_pad[:, None, :, :], axes=(1, 2))
        kf_f = (lambda x, axes=(-2,-1): torch.fft.rfft2(x.float(), dim=axes))(kf_pad[:, None, :], axes=(1, 2))
        kf_f = (lambda x, *d: x.permute(*d))(kf_f, 1, 2, 0)
        y_f = kv_f * kf_f[None, :, :, :]
        y = (lambda x, s, axes=(-2,-1): torch.fft.irfft2(x, s=s, dim=axes).to(torch.bfloat16))(y_f, (1, L), axes=(1, 2))[:, 0, :S, :]
        y = y + kv * ssm_D[None, None, :]
        return q * y

    def _B_ref(x, w_gate, w_up, w_down):
        g = _silu(x @ w_gate)
        u = x @ w_up
        return (g * u) @ w_down

    x = A_q
    h = x + _A_ref(_layernorm(x, axis=-1), A_k, A_v, A_shift_k, A_ssm_k, A_ssm_D)
    h2 = h + _B_ref(_layernorm(h, axis=-1), B_w_gate, B_w_up, B_w_down)
    return h2
```

```asm
; @launch kernel=sequential_preLN__ssm_conv_h3__swiglu_ffn__prompt_kernel grid=(256,1,1) block=(256,1,1) lds=149504
.amdgcn_target "amdgcn-amd-amdhsa--gfx950"
.text
.globl sequential_preLN__ssm_conv_h3__swiglu_ffn__prompt_kernel
.p2align 8
.type sequential_preLN__ssm_conv_h3__swiglu_ffn__prompt_kernel,@function
sequential_preLN__ssm_conv_h3__swiglu_ffn__prompt_kernel:
  s_cmp_ge_u32 s2, 256
  s_cbranch_scc1 L1_end
  s_load_dwordx2 s[4:5], s[0:1], 0
  s_load_dwordx2 s[20:21], s[0:1], 96
  s_load_dwordx2 s[16:17], s[0:1], 88
  s_cmp_lt_u32 s2, 224
  s_cbranch_scc1 L1_npf
  s_getpc_b64 s[56:57]
Lpc_conv_kernel:
  s_mov_b32 s58, Lcode_end-Lpc_conv_kernel
  s_mov_b32 s59, 0x20000
  s_and_b32 s57, s57, 0xffff
  v_lshlrev_b32 v254, 7, v0
  s_mov_b32 s55, 32768
  buffer_load_dword v252, v254, s[56:59], s55 offen
  buffer_load_dword v254, v254, s[56:59], 0 offen
L1_npf:
  v_lshrrev_b32 v1, 6, v0
  v_and_b32 v2, 63, v0
  s_and_b32 s60, s2, 7
  s_lshr_b32 s61, s2, 3
  v_readfirstlane_b32 s3, v1
  s_mov_b32 s22, 25100288
  s_mov_b32 s23, 0x20000
  s_mov_b32 s18, 256
  s_mov_b32 s19, 0x20000
  s_movk_i32 s62, 1280
  s_cmp_ge_u32 s61, 28
  s_cbranch_scc1 L1_wd
  s_cmp_ge_u32 s61, 8
  s_cbranch_scc1 L1_c
  s_and_b32 s63, s3, 1
  s_lshr_b32 s64, s3, 1
  s_lshl3_add_u32 s29, s63, 56
  s_load_dwordx2 s[8:9], s[0:1], s29
  s_mov_b32 s6, 2621440
  s_mov_b32 s7, 0x20000
  s_mov_b32 s10, 2211840
  s_mov_b32 s11, 0x20000
  v_and_b32 v4, 7, v2
  v_lshrrev_b32 v5, 3, v2
  s_lshl_b32 s30, s2, 5
  v_lshl_add_u32 v6, v5, 2, s30
  v_mul_u32_u24 v6, s62, v6
  v_xor_b32 v17, v4, v5
  v_lshl_add_u32 v6, v17, 4, v6
  v_and_b32 v7, 28, v2
  v_lshrrev_b32 v18, 5, v2
  v_add3_u32 v7, v7, v18, s30
  v_mul_u32_u24 v7, s62, v7
  v_and_b32 v18, 3, v2
  v_lshl_add_u32 v7, v18, 4, v7
  s_mul_i32 s50, s3, 10240
  s_add_u32 s50, s50, 81920
  s_mul_i32 s30, s3, 320
  s_lshl_b32 s31, s63, 6
  s_add_u32 s31, s31, s30
  s_xor_b32 s32, s63, 1
  s_lshl_b32 s32, s32, 8
  s_add_u32 s32, s32, s30
  s_waitcnt lgkmcnt(0)
  s_and_b32 s5, s5, 0xffff
  s_mov_b32 m0, s50
  s_nop 0
  buffer_load_dwordx4 v6, s[4:7], s31 offen offset:0 nt lds
  s_add_u32 m0, s50, 896
  s_nop 0
  buffer_load_dwordx4 v6, s[4:7], s31 offen offset:128 nt lds
  s_add_u32 m0, s50, 8192
  s_nop 0
  buffer_load_dwordx4 v7, s[4:7], s32 offen offset:0 nt lds
  s_add_u32 m0, s50, 768
  s_nop 0
  buffer_load_dwordx4 v6, s[4:7], s31 offen offset:1280 nt lds
  s_add_u32 m0, s50, 1664
  s_nop 0
  buffer_load_dwordx4 v6, s[4:7], s31 offen offset:1408 nt lds
  s_add_u32 m0, s50, 1536
  s_nop 0
  buffer_load_dwordx4 v6, s[4:7], s31 offen offset:2560 nt lds
  s_add_u32 m0, s50, 2432
  s_nop 0
  buffer_load_dwordx4 v6, s[4:7], s31 offen offset:2688 nt lds
  s_add_u32 m0, s50, 6656
  s_nop 0
  buffer_load_dwordx4 v7, s[4:7], s32 offen offset:2560 nt lds
  s_add_u32 m0, s50, 2304
  s_nop 0
  buffer_load_dwordx4 v6, s[4:7], s31 offen offset:3840 nt lds
  s_add_u32 m0, s50, 3200
  s_nop 0
  buffer_load_dwordx4 v6, s[4:7], s31 offen offset:3968 nt lds
  s_lshr_b32 s65, s60, 1
  s_and_b32 s66, s61, 3
  s_lshl2_add_u32 s65, s65, s66
  s_and_b32 s66, s60, 1
  s_lshr_b32 s67, s61, 2
  s_lshl1_add_u32 s66, s66, s67
  s_and_b32 s67, s65, 1
  v_lshrrev_b32 v8, 4, v2
  v_and_b32 v9, 15, v2
  v_lshlrev_b32 v10, 1, v8
  v_xor_b32 v9, v9, v10
  s_movk_i32 s33, 3456
  v_mul_u32_u24 v8, s33, v8
  v_lshl_add_u32 v8, v9, 4, v8
  v_xor_b32 v10, 8, v9
  v_subrev_u32 v11, v9, v10
  v_lshl_add_u32 v11, v11, 4, v8
  s_cmp_eq_u32 s65, 15
  s_cselect_b32 s34, 8, 16
  v_mov_b32 v12, 0x7ff00000
  v_cmp_le_u32 vcc, s34, v9
  s_nop 1
  v_cndmask_b32 v8, v8, v12, vcc
  v_cmp_le_u32 vcc, s34, v10
  s_nop 1
  v_cndmask_b32 v9, v11, v12, vcc
  s_lshl1_add_u32 s34, s66, s64
  s_mul_i32 s34, s34, 276480
  s_lshr_b32 s35, s65, 1
  s_mul_i32 s35, s35, 448
  s_add_u32 s34, s34, s35
  s_mul_i32 s35, s67, 192
  s_add_u32 s34, s34, s35
  s_mul_i32 s35, s63, 40960
  s_mul_i32 s36, s64, 20480
  s_add_u32 s36, s36, s35
  s_and_b32 s9, s9, 0xffff
  s_and_b32 s17, s17, 0xffff
  s_and_b32 s21, s21, 0xffff
  s_lshl2_add_u32 s37, s2, s3
  s_lshl_b32 s37, s37, 6
  s_add_u32 s37, s37, 22134784
  v_mov_b32 v12, 0
  v_lshlrev_b32 v13, 2, v2
  s_mov_b64 exec, 0xffff
  buffer_store_dword v12, v13, s[20:23], s37 offen sc1
  v_lshrrev_b32 v13, 2, v2
  v_lshl_add_u32 v13, s3, 2, v13
  v_cmp_gt_u32 vcc, 4, v13
  v_mul_u32_u24 v13, 65792, v13
  v_and_b32 v14, 3, v2
  v_mul_u32_u24 v14, 256, v14
  v_add_u32 v13, v13, v14
  v_mov_b32 v14, 0x7ff00000
  v_cndmask_b32 v13, v14, v13, vcc
  s_mul_i32 s37, s2, 1024
  s_add_u32 s37, s37, 4194304
  buffer_store_dword v12, v13, s[20:23], s37 offen sc1
  s_mov_b64 exec, -1
  s_lshl2_add_u32 s78, s65, s66
  s_add_u32 s78, s78, 160
  v_mov_b32 v12, 0x3f803f80
  v_mov_b32 v64, 0
  v_mov_b32 v65, 0
  v_mov_b32 v66, 0
  v_mov_b32 v67, 0
  v_mov_b32 v68, 0
  v_mov_b32 v69, 0
  v_mov_b32 v70, 0
  v_mov_b32 v71, 0
  v_lshlrev_b32 v13, 5, v4
  v_add_u32 v13, 122880, v13
  s_lshl_b32 s37, s3, 8
  v_add_u32 v14, s37, v13
  v_lshlrev_b32 v15, 5, v4
  s_lshl_b32 s38, s2, 8
  s_add_u32 s38, s38, 3145728
  v_lshlrev_b32 v19, 4, v4
  v_lshl_add_u32 v16, v5, 8, v19
  v_lshl_add_u32 v19, v5, 9, v19
  s_mul_i32 s37, s2, 41088
  s_add_u32 s37, s37, 0
  s_lshl_b32 s51, s31, 5
  s_add_u32 s51, s51, s37
  s_add_u32 s52, s51, 4096
  s_lshl_b32 s53, s32, 5
  s_add_u32 s53, s53, s37
  s_mov_b32 s41, 0x05040100
  s_mov_b32 s42, 0x07060302
  v_lshlrev_b32 v17, 4, v17
  v_lshl_add_u32 v17, v4, 7, v17
  v_add_u32 v17, s50, v17
  v_lshlrev_b32 v18, 3, v5
  v_lshl_add_u32 v18, v4, 6, v18
  v_add_u32 v18, s50, v18
  s_waitcnt vmcnt(9)
  ds_read_b128 v[24:27], v17 offset:0
  ds_read_b128 v[28:31], v17 offset:1024
  ds_read_b64 v[32:33], v18 offset:8192
  s_waitcnt vmcnt(7)
  ds_read_b128 v[34:37], v17 offset:2048
  ds_read_b128 v[38:41], v17 offset:3072
  ds_read_b64 v[42:43], v18 offset:8704
  s_waitcnt vmcnt(4)
  ds_read_b128 v[44:47], v17 offset:4096
  ds_read_b128 v[48:51], v17 offset:5120
  ds_read_b64 v[52:53], v18 offset:9216
  s_waitcnt vmcnt(2)
  ds_read_b128 v[54:57], v17 offset:6144
  ds_read_b128 v[58:61], v17 offset:7168
  ds_read_b64 v[62:63], v18 offset:9728
  s_waitcnt lgkmcnt(11)
  v_dot2c_f32_bf16 v64, v12, v24
  v_dot2c_f32_bf16 v65, v24, v24
  v_dot2c_f32_bf16 v64, v12, v25
  v_dot2c_f32_bf16 v65, v25, v25
  v_dot2c_f32_bf16 v64, v12, v26
  v_dot2c_f32_bf16 v65, v26, v26
  v_dot2c_f32_bf16 v64, v12, v27
  v_dot2c_f32_bf16 v65, v27, v27
  s_waitcnt lgkmcnt(10)
  v_dot2c_f32_bf16 v64, v12, v28
  v_dot2c_f32_bf16 v65, v28, v28
  v_dot2c_f32_bf16 v64, v12, v29
  v_dot2c_f32_bf16 v65, v29, v29
  v_dot2c_f32_bf16 v64, v12, v30
  v_dot2c_f32_bf16 v65, v30, v30
  v_dot2c_f32_bf16 v64, v12, v31
  v_dot2c_f32_bf16 v65, v31, v31
  s_waitcnt lgkmcnt(9)
  v_dot2c_f32_bf16 v64, v12, v32
  v_dot2c_f32_bf16 v65, v32, v32
  v_dot2c_f32_bf16 v64, v12, v33
  v_dot2c_f32_bf16 v65, v33, v33
  s_waitcnt lgkmcnt(8)
  v_dot2c_f32_bf16 v66, v12, v34
  v_dot2c_f32_bf16 v67, v34, v34
  v_dot2c_f32_bf16 v66, v12, v35
  v_dot2c_f32_bf16 v67, v35, v35
  v_dot2c_f32_bf16 v66, v12, v36
  v_dot2c_f32_bf16 v67, v36, v36
  v_dot2c_f32_bf16 v66, v12, v37
  v_dot2c_f32_bf16 v67, v37, v37
  s_waitcnt lgkmcnt(7)
  v_dot2c_f32_bf16 v66, v12, v38
  v_dot2c_f32_bf16 v67, v38, v38
  v_dot2c_f32_bf16 v66, v12, v39
  v_dot2c_f32_bf16 v67, v39, v39
  v_dot2c_f32_bf16 v66, v12, v40
  v_dot2c_f32_bf16 v67, v40, v40
  v_dot2c_f32_bf16 v66, v12, v41
  v_dot2c_f32_bf16 v67, v41, v41
  s_waitcnt lgkmcnt(6)
  v_dot2c_f32_bf16 v66, v12, v42
  v_dot2c_f32_bf16 v67, v42, v42
  v_dot2c_f32_bf16 v66, v12, v43
  v_dot2c_f32_bf16 v67, v43, v43
  s_waitcnt lgkmcnt(5)
  v_dot2c_f32_bf16 v68, v12, v44
  v_dot2c_f32_bf16 v69, v44, v44
  v_dot2c_f32_bf16 v68, v12, v45
  v_dot2c_f32_bf16 v69, v45, v45
  v_dot2c_f32_bf16 v68, v12, v46
  v_dot2c_f32_bf16 v69, v46, v46
  v_dot2c_f32_bf16 v68, v12, v47
  v_dot2c_f32_bf16 v69, v47, v47
  s_waitcnt lgkmcnt(4)
  v_dot2c_f32_bf16 v68, v12, v48
  v_dot2c_f32_bf16 v69, v48, v48
  v_dot2c_f32_bf16 v68, v12, v49
  v_dot2c_f32_bf16 v69, v49, v49
  v_dot2c_f32_bf16 v68, v12, v50
  v_dot2c_f32_bf16 v69, v50, v50
  v_dot2c_f32_bf16 v68, v12, v51
  v_dot2c_f32_bf16 v69, v51, v51
  s_waitcnt lgkmcnt(3)
  v_dot2c_f32_bf16 v68, v12, v52
  v_dot2c_f32_bf16 v69, v52, v52
  v_dot2c_f32_bf16 v68, v12, v53
  v_dot2c_f32_bf16 v69, v53, v53
  s_waitcnt lgkmcnt(2)
  v_dot2c_f32_bf16 v70, v12, v54
  v_dot2c_f32_bf16 v71, v54, v54
  v_dot2c_f32_bf16 v70, v12, v55
  v_dot2c_f32_bf16 v71, v55, v55
  v_dot2c_f32_bf16 v70, v12, v56
  v_dot2c_f32_bf16 v71, v56, v56
  v_dot2c_f32_bf16 v70, v12, v57
  v_dot2c_f32_bf16 v71, v57, v57
  s_waitcnt lgkmcnt(1)
  v_dot2c_f32_bf16 v70, v12, v58
  v_dot2c_f32_bf16 v71, v58, v58
  v_dot2c_f32_bf16 v70, v12, v59
  v_dot2c_f32_bf16 v71, v59, v59
  v_dot2c_f32_bf16 v70, v12, v60
  v_dot2c_f32_bf16 v71, v60, v60
  v_dot2c_f32_bf16 v70, v12, v61
  v_dot2c_f32_bf16 v71, v61, v61
  s_waitcnt lgkmcnt(0)
  v_dot2c_f32_bf16 v70, v12, v62
  v_dot2c_f32_bf16 v71, v62, v62
  v_dot2c_f32_bf16 v70, v12, v63
  v_dot2c_f32_bf16 v71, v63, v63
  v_add_f32_dpp v64, v64, v64 row_ror:8 row_mask:0xf bank_mask:0xf
  v_add_f32_dpp v65, v65, v65 row_ror:8 row_mask:0xf bank_mask:0xf
  v_add_f32_dpp v66, v66, v66 row_ror:8 row_mask:0xf bank_mask:0xf
  v_add_f32_dpp v67, v67, v67 row_ror:8 row_mask:0xf bank_mask:0xf
  v_add_f32_dpp v68, v68, v68 row_ror:8 row_mask:0xf bank_mask:0xf
  v_add_f32_dpp v69, v69, v69 row_ror:8 row_mask:0xf bank_mask:0xf
  v_add_f32_dpp v70, v70, v70 row_ror:8 row_mask:0xf bank_mask:0xf
  v_add_f32_dpp v71, v71, v71 row_ror:8 row_mask:0xf bank_mask:0xf
  v_mov_b32 v72, v64
  v_mov_b32 v73, v65
  v_mov_b32 v74, v66
  v_mov_b32 v75, v67
  v_mov_b32 v76, v68
  v_mov_b32 v77, v69
  v_mov_b32 v78, v70
  v_mov_b32 v79, v71
  v_permlane16_swap_b32 v64, v72
  v_permlane16_swap_b32 v65, v73
  v_permlane16_swap_b32 v66, v74
  v_permlane16_swap_b32 v67, v75
  v_permlane16_swap_b32 v68, v76
  v_permlane16_swap_b32 v69, v77
  v_permlane16_swap_b32 v70, v78
  v_permlane16_swap_b32 v71, v79
  v_add_f32 v64, v64, v72
  v_add_f32 v65, v65, v73
  v_add_f32 v66, v66, v74
  v_add_f32 v67, v67, v75
  v_add_f32 v68, v68, v76
  v_add_f32 v69, v69, v77
  v_add_f32 v70, v70, v78
  v_add_f32 v71, v71, v79
  v_mov_b32 v72, v64
  v_mov_b32 v73, v65
  v_mov_b32 v74, v66
  v_mov_b32 v75, v67
  v_mov_b32 v76, v68
  v_mov_b32 v77, v69
  v_mov_b32 v78, v70
  v_mov_b32 v79, v71
  v_permlane32_swap_b32 v64, v72
  v_permlane32_swap_b32 v65, v73
  v_permlane32_swap_b32 v66, v74
  v_permlane32_swap_b32 v67, v75
  v_permlane32_swap_b32 v68, v76
  v_permlane32_swap_b32 v69, v77
  v_permlane32_swap_b32 v70, v78
  v_permlane32_swap_b32 v71, v79
  v_add_f32 v64, v64, v72
  v_add_f32 v65, v65, v73
  v_add_f32 v66, v66, v74
  v_add_f32 v67, v67, v75
  v_add_f32 v68, v68, v76
  v_add_f32 v69, v69, v77
  v_add_f32 v70, v70, v78
  v_add_f32 v71, v71, v79
  s_mov_b64 exec, 0xff
  ds_write_b128 v14, v[64:67]
  ds_write_b128 v14, v[68:71] offset:16
  s_mov_b64 exec, -1
  v_perm_b32 v100, v34, v24, s41
  v_perm_b32 v101, v54, v44, s41
  v_perm_b32 v102, v34, v24, s42
  v_perm_b32 v103, v54, v44, s42
  buffer_store_dwordx4 v[100:103], v19, s[20:23], s51 offen offset:0 sc1
  v_perm_b32 v104, v35, v25, s41
  v_perm_b32 v105, v55, v45, s41
  v_perm_b32 v106, v35, v25, s42
  v_perm_b32 v107, v55, v45, s42
  buffer_store_dwordx4 v[104:107], v19, s[20:23], s51 offen offset:128 sc1
  v_perm_b32 v108, v36, v26, s41
  v_perm_b32 v109, v56, v46, s41
  v_perm_b32 v110, v36, v26, s42
  v_perm_b32 v111, v56, v46, s42
  buffer_store_dwordx4 v[108:111], v19, s[20:23], s51 offen offset:256 sc1
  v_perm_b32 v112, v37, v27, s41
  v_perm_b32 v113, v57, v47, s41
  v_perm_b32 v114, v37, v27, s42
  v_perm_b32 v115, v57, v47, s42
  buffer_store_dwordx4 v[112:115], v19, s[20:23], s51 offen offset:384 sc1
  v_perm_b32 v116, v38, v28, s41
  v_perm_b32 v117, v58, v48, s41
  v_perm_b32 v118, v38, v28, s42
  v_perm_b32 v119, v58, v48, s42
  buffer_store_dwordx4 v[116:119], v19, s[20:23], s52 offen offset:0 sc1
  v_perm_b32 v120, v39, v29, s41
  v_perm_b32 v121, v59, v49, s41
  v_perm_b32 v122, v39, v29, s42
  v_perm_b32 v123, v59, v49, s42
  buffer_store_dwordx4 v[120:123], v19, s[20:23], s52 offen offset:128 sc1
  v_perm_b32 v124, v40, v30, s41
  v_perm_b32 v125, v60, v50, s41
  v_perm_b32 v126, v40, v30, s42
  v_perm_b32 v127, v60, v50, s42
  buffer_store_dwordx4 v[124:127], v19, s[20:23], s52 offen offset:256 sc1
  v_perm_b32 v128, v41, v31, s41
  v_perm_b32 v129, v61, v51, s41
  v_perm_b32 v130, v41, v31, s42
  v_perm_b32 v131, v61, v51, s42
  buffer_store_dwordx4 v[128:131], v19, s[20:23], s52 offen offset:384 sc1
  v_perm_b32 v132, v42, v32, s41
  v_perm_b32 v133, v62, v52, s41
  v_perm_b32 v134, v42, v32, s42
  v_perm_b32 v135, v62, v52, s42
  buffer_store_dwordx4 v[132:135], v16, s[20:23], s53 offen offset:0 sc1
  v_perm_b32 v136, v43, v33, s41
  v_perm_b32 v137, v63, v53, s41
  v_perm_b32 v138, v43, v33, s42
  v_perm_b32 v139, v63, v53, s42
  buffer_store_dwordx4 v[136:139], v16, s[20:23], s53 offen offset:128 sc1
  s_waitcnt lgkmcnt(0)
  s_barrier
  ds_read_b128 v[64:67], v13 offset:0
  ds_read_b128 v[68:71], v13 offset:16
  ds_read_b128 v[72:75], v13 offset:256
  ds_read_b128 v[76:79], v13 offset:272
  ds_read_b128 v[80:83], v13 offset:512
  ds_read_b128 v[84:87], v13 offset:528
  ds_read_b128 v[88:91], v13 offset:768
  ds_read_b128 v[92:95], v13 offset:784
  s_cmp_eq_u32 s3, 0
  s_cselect_b32 s39, 0, 0x7ff00000
  v_or_b32 v15, s39, v15
  s_waitcnt lgkmcnt(5)
  v_pk_add_f32 v[64:65], v[64:65], v[72:73]
  s_waitcnt lgkmcnt(1)
  v_pk_add_f32 v[80:81], v[80:81], v[88:89]
  v_pk_add_f32 v[66:67], v[66:67], v[74:75]
  v_pk_add_f32 v[82:83], v[82:83], v[90:91]
  v_pk_add_f32 v[68:69], v[68:69], v[76:77]
  s_waitcnt lgkmcnt(0)
  v_pk_add_f32 v[84:85], v[84:85], v[92:93]
  v_pk_add_f32 v[70:71], v[70:71], v[78:79]
  v_pk_add_f32 v[86:87], v[86:87], v[94:95]
  v_pk_add_f32 v[64:65], v[64:65], v[80:81]
  v_pk_add_f32 v[66:67], v[66:67], v[82:83]
  v_pk_add_f32 v[68:69], v[68:69], v[84:85]
  v_pk_add_f32 v[70:71], v[70:71], v[86:87]
  v_mul_f32 v64, 0xbacccccd, v64
  v_mul_f32 v65, 0x3acccccd, v65
  v_mul_f32 v66, 0xbacccccd, v66
  v_mul_f32 v67, 0x3acccccd, v67
  v_mul_f32 v68, 0xbacccccd, v68
  v_mul_f32 v69, 0x3acccccd, v69
  v_mul_f32 v70, 0xbacccccd, v70
  v_mul_f32 v71, 0x3acccccd, v71
  v_fma_f32 v65, -v64, v64, v65
  v_max_f32 v65, 0, v65
  v_add_f32 v65, 0x3727c5ac, v65
  v_fma_f32 v67, -v66, v66, v67
  v_max_f32 v67, 0, v67
  v_add_f32 v67, 0x3727c5ac, v67
  v_fma_f32 v69, -v68, v68, v69
  v_max_f32 v69, 0, v69
  v_add_f32 v69, 0x3727c5ac, v69
  v_fma_f32 v71, -v70, v70, v71
  v_max_f32 v71, 0, v71
  v_add_f32 v71, 0x3727c5ac, v71
  v_rsq_f32 v65, v65
  v_rsq_f32 v67, v67
  v_rsq_f32 v69, v69
  v_rsq_f32 v71, v71
  v_mul_f32 v64, v64, v65
  v_mul_f32 v66, v66, v67
  v_mul_f32 v68, v68, v69
  v_mul_f32 v70, v70, v71
  s_mov_b64 exec, 0xff
  buffer_store_dwordx4 v[64:67], v15, s[20:23], s38 offen offset:0 sc1
  buffer_store_dwordx4 v[68:71], v15, s[20:23], s38 offen offset:16 sc1
  s_mov_b64 exec, -1
  v_and_b32 v4, 3, v2
  v_lshrrev_b32 v5, 2, v2
  v_and_b32 v6, 7, v5
  v_lshlrev_b32 v6, 5, v6
  v_lshlrev_b32 v5, 8, v5
  s_add_u32 s37, s67, s64
  s_lshl_b32 s37, s37, 6
  v_lshl_add_u32 v7, v4, 3, s37
  v_xor_b32 v20, v7, v6
  v_add3_u32 v20, v20, v5, s35
  v_xor_b32 v21, 32, v20
  s_lshl_b32 s37, s67, 6
  s_lshl4_add_u32 s37, s64, s37
  s_add_u32 s37, s37, 128
  v_lshrrev_b32 v10, 1, v4
  v_and_b32 v11, 1, v4
  v_lshl_add_u32 v7, v10, 5, s37
  v_lshl_add_u32 v7, v11, 3, v7
  v_xor_b32 v22, v7, v6
  v_add3_u32 v22, v22, v5, s35
  s_cmp_eq_u32 s67, 1
  s_cselect_b32 s37, 16, 192
  s_lshl3_add_u32 s37, s64, s37
  v_lshl_add_u32 v7, v11, 5, s37
  v_xor_b32 v23, v7, v6
  v_add_u32 v23, v23, v5
  v_mul_u32_u24 v10, 40960, v10
  v_add_u32 v23, v23, v10
  v_lshlrev_b32 v3, 4, v2
  v_lshrrev_b32 v4, 4, v2
  v_lshlrev_b32 v4, 4, v4
  v_mov_b32 v5, 1
  v_mov_b32 v6, s39
  s_lshl_b32 s44, s2, 2
  v_mov_b32 v12, 0x3f803f80
  v_mov_b32 v13, 0x3f803f80
  v_mov_b32 v14, 0x3f803f80
  v_mov_b32 v15, 0x3f803f80
  s_mul_i32 s37, s65, 286720
  s_mul_i32 s45, s66, 71680
  s_add_u32 s37, s37, s45
  s_add_u32 s37, s37, 7872512
  s_mul_i32 s45, s64, 7
  s_mul_i32 s46, s63, 3
  s_add_u32 s45, s45, s46
  s_lshl_b32 s46, s45, 10
  s_add_u32 s37, s37, s46
  s_mul_i32 s46, s66, 14336
  s_mul_i32 s47, s65, 896
  s_add_u32 s46, s46, s47
  s_lshl_b32 s47, s45, 6
  s_add_u32 s46, s46, s47
  s_add_u32 s46, s46, 14671872
  s_waitcnt vmcnt(0)
  s_barrier
  s_mov_b64 exec, 1
  buffer_store_dword v5, v6, s[16:19], s44 offen sc1
  s_mov_b64 exec, -1
  s_add_u32 m0, s36, 0
  s_nop 0
  buffer_load_dwordx4 v8, s[8:11], s34 offen lds
  s_add_u32 s34, s34, 13824
  s_add_u32 m0, s36, 1024
  s_nop 0
  buffer_load_dwordx4 v9, s[8:11], s34 offen lds
  s_add_u32 s34, s34, 13824
  s_add_u32 m0, s36, 2048
  s_nop 0
  buffer_load_dwordx4 v8, s[8:11], s34 offen lds
  s_add_u32 s34, s34, 13824
  s_add_u32 m0, s36, 3072
  s_nop 0
  buffer_load_dwordx4 v9, s[8:11], s34 offen lds
  s_add_u32 s34, s34, 13824
  s_add_u32 m0, s36, 4096
  s_nop 0
  buffer_load_dwordx4 v8, s[8:11], s34 offen lds
  s_add_u32 s34, s34, 13824
  s_add_u32 m0, s36, 5120
  s_nop 0
  buffer_load_dwordx4 v9, s[8:11], s34 offen lds
  s_add_u32 s34, s34, 13824
  s_add_u32 m0, s36, 6144
  s_nop 0
  buffer_load_dwordx4 v8, s[8:11], s34 offen lds
  s_add_u32 s34, s34, 13824
  s_add_u32 m0, s36, 7168
  s_nop 0
  buffer_load_dwordx4 v9, s[8:11], s34 offen lds
  s_add_u32 s34, s34, 13824
  s_add_u32 m0, s36, 8192
  s_nop 0
  buffer_load_dwordx4 v8, s[8:11], s34 offen lds
  s_add_u32 s34, s34, 13824
  s_add_u32 m0, s36, 9216
  s_nop 0
  buffer_load_dwordx4 v9, s[8:11], s34 offen lds
  s_add_u32 s34, s34, 13824
  s_add_u32 m0, s36, 10240
  s_nop 0
  buffer_load_dwordx4 v8, s[8:11], s34 offen lds
  s_add_u32 s34, s34, 13824
  s_add_u32 m0, s36, 11264
  s_nop 0
  buffer_load_dwordx4 v9, s[8:11], s34 offen lds
  s_add_u32 s34, s34, 13824
  s_add_u32 m0, s36, 12288
  s_nop 0
  buffer_load_dwordx4 v8, s[8:11], s34 offen lds
  s_add_u32 s34, s34, 13824
  s_add_u32 m0, s36, 13312
  s_nop 0
  buffer_load_dwordx4 v9, s[8:11], s34 offen lds
  s_add_u32 s34, s34, 13824
  s_add_u32 m0, s36, 14336
  s_nop 0
  buffer_load_dwordx4 v8, s[8:11], s34 offen lds
  s_add_u32 s34, s34, 13824
  s_add_u32 m0, s36, 15360
  s_nop 0
  buffer_load_dwordx4 v9, s[8:11], s34 offen lds
  s_add_u32 s34, s34, 13824
  s_add_u32 m0, s36, 16384
  s_nop 0
  buffer_load_dwordx4 v8, s[8:11], s34 offen lds
  s_add_u32 s34, s34, 13824
  s_add_u32 m0, s36, 17408
  s_nop 0
  buffer_load_dwordx4 v9, s[8:11], s34 offen lds
  s_add_u32 s34, s34, 13824
  s_add_u32 m0, s36, 18432
  s_nop 0
  buffer_load_dwordx4 v8, s[8:11], s34 offen lds
  s_add_u32 s34, s34, 13824
  s_add_u32 m0, s36, 19456
  s_nop 0
  buffer_load_dwordx4 v9, s[8:11], s34 offen lds
  v_lshlrev_b32 v16, 2, v2
  s_waitcnt vmcnt(0)
  s_barrier
  buffer_load_dword v17, v16, s[16:19], 0 offen sc1
  ds_read_b64_tr_b16 v[24:25], v20 offset:0
  ds_read_b64_tr_b16 v[26:27], v20 offset:4096
  ds_read_b64_tr_b16 v[28:29], v21 offset:0
  ds_read_b64_tr_b16 v[30:31], v21 offset:4096
  ds_read_b64_tr_b16 v[32:33], v22 offset:0
  ds_read_b64_tr_b16 v[34:35], v22 offset:4096
  ds_read_b64_tr_b16 v[36:37], v20 offset:8192
  ds_read_b64_tr_b16 v[38:39], v20 offset:12288
  ds_read_b64_tr_b16 v[40:41], v21 offset:8192
  ds_read_b64_tr_b16 v[42:43], v21 offset:12288
  ds_read_b64_tr_b16 v[44:45], v22 offset:8192
  ds_read_b64_tr_b16 v[46:47], v22 offset:12288
  ds_read_b64_tr_b16 v[48:49], v20 offset:16384
  ds_read_b64_tr_b16 v[50:51], v20 offset:20480
  ds_read_b64_tr_b16 v[52:53], v21 offset:16384
  ds_read_b64_tr_b16 v[54:55], v21 offset:20480
  ds_read_b64_tr_b16 v[56:57], v22 offset:16384
  ds_read_b64_tr_b16 v[58:59], v22 offset:20480
  ds_read_b64_tr_b16 v[60:61], v20 offset:24576
  ds_read_b64_tr_b16 v[62:63], v20 offset:28672
  ds_read_b64_tr_b16 v[64:65], v21 offset:24576
  ds_read_b64_tr_b16 v[66:67], v21 offset:28672
  ds_read_b64_tr_b16 v[68:69], v22 offset:24576
  ds_read_b64_tr_b16 v[70:71], v22 offset:28672
  ds_read_b64_tr_b16 v[72:73], v20 offset:32768
  ds_read_b64_tr_b16 v[74:75], v20 offset:36864
  ds_read_b64_tr_b16 v[76:77], v21 offset:32768
  ds_read_b64_tr_b16 v[78:79], v21 offset:36864
  ds_read_b64_tr_b16 v[80:81], v22 offset:32768
  ds_read_b64_tr_b16 v[82:83], v22 offset:36864
  ds_read_b64_tr_b16 v[84:85], v23 offset:0
  ds_read_b64_tr_b16 v[86:87], v23 offset:4096
  ds_read_b64_tr_b16 v[88:89], v23 offset:8192
  ds_read_b64_tr_b16 v[90:91], v23 offset:12288
  ds_read_b64_tr_b16 v[92:93], v23 offset:16384
  ds_read_b64_tr_b16 v[94:95], v23 offset:20480
  ds_read_b64_tr_b16 v[96:97], v23 offset:24576
  ds_read_b64_tr_b16 v[98:99], v23 offset:28672
  ds_read_b64_tr_b16 v[100:101], v23 offset:32768
  ds_read_b64_tr_b16 v[102:103], v23 offset:36864
  s_mov_b32 s47, s37
  s_waitcnt lgkmcnt(15)
  buffer_store_dwordx4 v[24:27], v3, s[20:23], s47 offen offset:0 sc1
  v_mfma_f32_16x16x32_bf16 v[120:123], v[24:27], v[12:15], 0
  buffer_store_dwordx4 v[28:31], v3, s[20:23], s47 offen offset:1024 sc1
  v_mfma_f32_16x16x32_bf16 v[124:127], v[28:31], v[12:15], 0
  buffer_store_dwordx4 v[32:35], v3, s[20:23], s47 offen offset:2048 sc1
  v_mfma_f32_16x16x32_bf16 v[128:131], v[32:35], v[12:15], 0
  s_add_u32 s47, s47, 14336
  buffer_store_dwordx4 v[36:39], v3, s[20:23], s47 offen offset:0 sc1
  v_mfma_f32_16x16x32_bf16 v[120:123], v[36:39], v[12:15], v[120:123]
  buffer_store_dwordx4 v[40:43], v3, s[20:23], s47 offen offset:1024 sc1
  v_mfma_f32_16x16x32_bf16 v[124:127], v[40:43], v[12:15], v[124:127]
  buffer_store_dwordx4 v[44:47], v3, s[20:23], s47 offen offset:2048 sc1
  v_mfma_f32_16x16x32_bf16 v[128:131], v[44:47], v[12:15], v[128:131]
  s_add_u32 s47, s47, 14336
  buffer_store_dwordx4 v[48:51], v3, s[20:23], s47 offen offset:0 sc1
  v_mfma_f32_16x16x32_bf16 v[120:123], v[48:51], v[12:15], v[120:123]
  buffer_store_dwordx4 v[52:55], v3, s[20:23], s47 offen offset:1024 sc1
  v_mfma_f32_16x16x32_bf16 v[124:127], v[52:55], v[12:15], v[124:127]
  buffer_store_dwordx4 v[56:59], v3, s[20:23], s47 offen offset:2048 sc1
  v_mfma_f32_16x16x32_bf16 v[128:131], v[56:59], v[12:15], v[128:131]
  s_add_u32 s47, s47, 14336
  buffer_store_dwordx4 v[60:63], v3, s[20:23], s47 offen offset:0 sc1
  v_mfma_f32_16x16x32_bf16 v[120:123], v[60:63], v[12:15], v[120:123]
  buffer_store_dwordx4 v[64:67], v3, s[20:23], s47 offen offset:1024 sc1
  v_mfma_f32_16x16x32_bf16 v[124:127], v[64:67], v[12:15], v[124:127]
  buffer_store_dwordx4 v[68:71], v3, s[20:23], s47 offen offset:2048 sc1
  v_mfma_f32_16x16x32_bf16 v[128:131], v[68:71], v[12:15], v[128:131]
  s_add_u32 s47, s47, 14336
  s_waitcnt lgkmcnt(14)
  buffer_store_dwordx4 v[72:75], v3, s[20:23], s47 offen offset:0 sc1
  v_mfma_f32_16x16x32_bf16 v[120:123], v[72:75], v[12:15], v[120:123]
  s_waitcnt lgkmcnt(12)
  buffer_store_dwordx4 v[76:79], v3, s[20:23], s47 offen offset:1024 sc1
  v_mfma_f32_16x16x32_bf16 v[124:127], v[76:79], v[12:15], v[124:127]
  s_waitcnt lgkmcnt(10)
  buffer_store_dwordx4 v[80:83], v3, s[20:23], s47 offen offset:2048 sc1
  v_mfma_f32_16x16x32_bf16 v[128:131], v[80:83], v[12:15], v[128:131]
  s_mov_b32 s48, 0x00010001
  s_mov_b32 s49, s48
  s_mov_b64 exec, s[48:49]
  buffer_store_dwordx4 v[120:123], v4, s[20:23], s46 offen offset:0 sc1
  s_nop 0
  buffer_store_dwordx4 v[124:127], v4, s[20:23], s46 offen offset:64 sc1
  s_nop 1
  buffer_store_dwordx4 v[128:131], v4, s[20:23], s46 offen offset:128 sc1
  s_mov_b64 exec, -1
  s_waitcnt lgkmcnt(0)
  s_waitcnt vmcnt(18)
  v_cmp_ne_u32 vcc, 0, v17
  s_nop 1
  s_cmp_eq_u64 vcc, -1
  s_cselect_b32 s77, 1, 0
  s_cmp_lg_u32 s63, 0
  s_cbranch_scc1 L1_x3
  s_add_u32 s47, s37, 6144
  buffer_store_dwordx4 v[84:87], v3, s[20:23], s47 offen sc1
  v_mfma_f32_16x16x32_bf16 v[132:135], v[84:87], v[12:15], 0
  s_add_u32 s47, s47, 14336
  buffer_store_dwordx4 v[88:91], v3, s[20:23], s47 offen sc1
  v_mfma_f32_16x16x32_bf16 v[132:135], v[88:91], v[12:15], v[132:135]
  s_add_u32 s47, s47, 14336
  buffer_store_dwordx4 v[92:95], v3, s[20:23], s47 offen sc1
  v_mfma_f32_16x16x32_bf16 v[132:135], v[92:95], v[12:15], v[132:135]
  s_add_u32 s47, s47, 14336
  buffer_store_dwordx4 v[96:99], v3, s[20:23], s47 offen sc1
  v_mfma_f32_16x16x32_bf16 v[132:135], v[96:99], v[12:15], v[132:135]
  s_add_u32 s47, s47, 14336
  buffer_store_dwordx4 v[100:103], v3, s[20:23], s47 offen sc1
  v_mfma_f32_16x16x32_bf16 v[132:135], v[100:103], v[12:15], v[132:135]
  s_mov_b64 exec, s[48:49]
  s_nop 6
  buffer_store_dwordx4 v[132:135], v4, s[20:23], s46 offen offset:384 sc1
L1_x3:
  s_mov_b64 exec, -1
  s_cmp_eq_u32 s77, 1
  s_cbranch_scc1 L2_join0
  s_branch L2_join1
L1_c:
  s_load_dwordx4 s[8:11], s[0:1], 8
  s_load_dwordx4 s[12:15], s[0:1], 24
  s_load_dwordx2 s[30:31], s[0:1], 40
  s_mul_i32 s63, s60, 20
  s_add_u32 s63, s63, s61
  s_sub_u32 s63, s63, 8
  s_mov_b32 s78, s63
  s_and_b32 s69, s63, 31
  s_lshr_b32 s70, s63, 5
  v_and_b32 v5, 15, v2
  v_lshrrev_b32 v6, 4, v2
  s_lshl_b32 s28, s69, 6
  s_lshl4_add_u32 s28, s3, s28
  v_lshl_add_u32 v7, v6, 2, s28
  v_cmp_eq_u32 vcc, 0, v7
  v_mul_u32_u24 v7, s62, v7
  s_lshl_b32 s29, s70, 8
  v_lshl_add_u32 v8, v5, 4, s29
  v_add_u32 v7, v7, v8
  v_subrev_u32 v9, 3840, v7
  v_mov_b32 v10, 0x7ff00000
  v_cndmask_b32 v9, v9, v10, vcc
  v_lshlrev_b32 v8, 2, v8
  s_mov_b32 s6, 2621440
  s_mov_b32 s7, 0x20000
  s_mov_b32 s26, 2621440
  s_mov_b32 s27, 0x20000
  s_mov_b32 s38, 5120
  s_mov_b32 s39, 0x20000
  s_mov_b32 s58, 2621440
  s_mov_b32 s59, 0x20000
  s_lshl_b32 s28, s69, 6
  v_and_b32 v238, 60, v2
  v_add_u32 v238, s28, v238
  v_mul_u32_u24 v238, s62, v238
  s_lshl_b32 s28, s3, 6
  s_add_u32 s28, s28, s29
  v_and_b32 v10, 3, v2
  v_lshl_add_u32 v10, v10, 4, s28
  v_add_u32 v238, v238, v10
  v_lshrrev_b32 v10, 3, v2
  v_mul_u32_u24 v10, 4224, v10
  v_and_b32 v11, 7, v2
  s_and_b32 s28, s3, 1
  s_lshl_b32 s28, s28, 2
  v_xor_b32 v11, s28, v11
  v_lshl_add_u32 v244, v11, 4, v10
  v_xor_b32 v245, 16, v244
  v_add_u32 v245, 33792, v245
  v_xor_b32 v246, 32, v244
  v_add_u32 v246, 67584, v246
  v_xor_b32 v247, 48, v244
  v_add_u32 v247, 101376, v247
  s_lshl2_add_u32 s71, s70, s3
  s_mul_i32 s71, s71, 135168
  s_lshl_b32 s28, s69, 7
  s_add_u32 s47, s71, s28
  s_add_u32 s47, s47, 0
  s_sub_u32 s71, s71, s28
  s_add_u32 s71, s71, 22155136
  v_mov_b32 v248, -1
  v_mov_b32 v249, -1
  v_mov_b32 v250, -1
  v_mov_b32 v251, -1
  v_lshlrev_b32 v4, 4, v2
  s_lshl2_add_u32 s64, s63, s3
  s_mul_i32 s65, s3, 12928
  s_lshl_b32 s66, s64, 12
  s_lshl_b32 s68, s64, 1
  s_and_b32 s68, s68, -4
  s_lshl_b32 s73, s70, 12
  s_add_u32 s73, s73, 24936448
  s_add_u32 s46, s73, 2048
  s_waitcnt lgkmcnt(0)
  s_mov_b32 s56, s4
  s_and_b32 s57, s5, 0xffff
  s_mov_b32 s4, s8
  s_and_b32 s5, s9, 0xffff
  buffer_load_dwordx4 v[96:99], v9, s[4:7], 0 offen offset:0
  buffer_load_dwordx4 v[100:103], v9, s[4:7], 0 offen offset:1280
  buffer_load_dwordx4 v[104:107], v9, s[4:7], 0 offen offset:2560
  buffer_load_dwordx4 v[108:111], v7, s[4:7], 0 offen offset:0
  buffer_load_dwordx4 v[112:115], v7, s[4:7], 0 offen offset:1280
  buffer_load_dwordx4 v[116:119], v7, s[4:7], 0 offen offset:2560
  buffer_load_dwordx4 v[120:123], v7, s[4:7], 0 offen offset:3840
  s_add_u32 s48, s20, s46
  s_addc_u32 s49, s21, 0
  s_load_dword s45, s[48:49], 0
  s_load_dword s29, s[30:31], s68
  s_and_b32 s21, s21, 0xffff
  s_mov_b32 s24, s10
  s_and_b32 s25, s11, 0xffff
  s_mov_b32 s36, s12
  s_and_b32 s37, s13, 0xffff
  s_add_u32 s12, s14, s66
  s_addc_u32 s13, s15, 0
  s_mov_b32 s14, 4096
  s_mov_b32 s15, 0x20000
  s_and_b32 s13, s13, 0xffff
  s_and_b32 s17, s17, 0xffff
  buffer_load_dwordx4 v[140:143], v8, s[36:39], 0 offen offset:0
  buffer_load_dwordx4 v[144:147], v8, s[36:39], 0 offen offset:16
  buffer_load_dwordx4 v[148:151], v8, s[36:39], 0 offen offset:32
  buffer_load_dwordx4 v[152:155], v8, s[36:39], 0 offen offset:48
  buffer_store_dwordx4 v[248:251], v244, s[20:23], s71 offen sc1
  buffer_store_dwordx4 v[248:251], v245, s[20:23], s71 offen sc1
  buffer_store_dwordx4 v[248:251], v246, s[20:23], s71 offen sc1
  buffer_store_dwordx4 v[248:251], v247, s[20:23], s71 offen sc1
  buffer_load_dwordx4 v[124:127], v7, s[24:27], 0 offen offset:0
  buffer_load_dwordx4 v[128:131], v7, s[24:27], 0 offen offset:1280
  buffer_load_dwordx4 v[132:135], v7, s[24:27], 0 offen offset:2560
  buffer_load_dwordx4 v[136:139], v7, s[24:27], 0 offen offset:3840
  s_lshr_b32 s28, s3, 1
  s_lshl3_add_u32 s28, s28, 56
  s_load_dwordx2 s[52:53], s[0:1], s28
  s_and_b32 s28, s60, 1
  s_mul_i32 s28, s28, 20
  s_add_u32 s28, s28, s61
  s_lshl_b32 s28, s28, 4
  s_sub_u32 s28, s28, 128
  v_bfe_u32 v237, v0, 3, 4
  v_add_u32 v237, s28, v237
  v_mul_u32_u24 v237, 27, v237
  v_and_b32 v236, 7, v2
  v_min_u32 v236, 6, v236
  s_lshr_b32 s28, s60, 1
  s_mul_i32 s28, s28, 7
  v_add3_u32 v237, v237, v236, s28
  v_lshlrev_b32 v237, 7, v237
  s_mov_b32 s54, 2211840
  s_mov_b32 s55, 0x20000
  v_add_u32 v10, 12416, v4
  v_and_b32 v11, 1, v2
  v_lshlrev_b32 v11, 4, v11
  v_add_u32 v12, 4160, v11
  v_cmp_gt_u32 vcc, 32, v2
  s_nop 1
  v_cndmask_b32 v11, v12, v11, vcc
  v_cmp_gt_u32 vcc, 30, v2
  s_nop 1
  v_cndmask_b32 v10, v11, v10, vcc
  v_add_u32 v10, s65, v10
  v_mov_b32 v76, 0
  v_mov_b32 v77, 0
  v_mov_b32 v78, 0
  v_mov_b32 v79, 0
  ds_write_b128 v10, v[76:79]
  v_and_b32 v11, 1, v5
  v_cmp_eq_u32 vcc, 1, v11
  v_mov_b32 v12, 4164
  v_mov_b32 v13, 2
  v_cndmask_b32 v12, v12, v13, vcc
  v_lshl_add_u32 v12, v5, 1, v12
  v_lshl_add_u32 v12, v6, 4, v12
  v_add_u32 v12, s65, v12
  v_add_u32 v13, 1024, v12
  v_add_u32 v14, 2048, v12
  v_add_u32 v15, 3072, v12
  v_lshlrev_b32 v11, 5, v5
  v_sub_u32 v11, 8800, v11
  v_lshl_add_u32 v11, v6, 4, v11
  v_add_u32 v11, s65, v11
  v_add_u32 v10, s65, v4
  s_lshl_b32 s28, s3, 2
  s_sub_u32 s28, 15, s28
  v_sub_u32 v9, s28, v6
  v_and_b32 v8, 7, v5
  v_lshlrev_b32 v8, 1, v8
  v_xor_b32 v9, v9, v8
  v_lshlrev_b32 v9, 3, v9
  v_lshl_add_u32 v9, v5, 10, v9
  v_add_u32 v9, 51712, v9
  s_lshl_b32 s28, s3, 12
  s_add_u32 s28, s28, 51712
  v_add_u32 v8, s28, v4
  v_lshrrev_b32 v16, 1, v5
  v_mul_u32_u24 v16, 41088, v16
  v_and_b32 v17, 1, v5
  v_lshl_add_u32 v17, v17, 2, v6
  v_lshl_add_u32 v16, v17, 4, v16
  s_lshr_b32 s33, s64, 1
  s_lshl_b32 s33, s33, 7
  s_and_b32 s28, s64, 1
  s_lshl3_add_u32 s33, s28, s33
  s_add_u32 s33, s33, 0
  v_lshlrev_b32 v1, 7, v5
  v_lshl_add_u32 v1, v6, 5, v1
  v_add_u32 v1, 84480, v1
  s_lshl_b32 s32, s3, 12
  s_add_u32 s40, s32, 84480
  s_add_u32 s32, s32, 3145728
  v_and_b32 v17, 3, v2
  v_lshrrev_b32 v236, 2, v2
  v_lshlrev_b32 v19, 1, v17
  v_xor_b32 v236, v236, v19
  s_and_b32 s28, s3, 1
  s_lshl_b32 s28, s28, 3
  v_xor_b32 v236, s28, v236
  v_lshlrev_b32 v236, 3, v236
  v_lshl_add_u32 v236, v17, 10, v236
  s_sub_u32 s28, s40, 16384
  v_add_u32 v236, s28, v236
  v_lshlrev_b32 v242, 2, v2
  v_and_b32 v18, 0x7c, v242
  s_lshl2_add_u32 s72, s69, s73
  s_cmp_eq_u32 s3, 0
  s_cselect_b32 s28, 0, 0x7ff00000
  v_mov_b32 v240, s28
  s_cmp_eq_u32 s69, 0
  s_cselect_b32 s28, s28, 0x7ff00000
  v_mov_b32 v241, s28
  s_mul_i32 s67, s64, 4224
  s_add_u32 s67, s67, 22151168
  s_mov_b32 s44, 200000
  s_cmp_eq_u32 s3, 0
  s_cselect_b64 s[50:51], 0, -1
  v_or_b32 v18, v240, v18
  v_or_b32 v242, v240, v242
  v_and_b32 v17, 1, v6
  v_lshlrev_b32 v17, 1, v17
  v_lshrrev_b32 v19, 3, v5
  v_add_u32 v17, v17, v19
  s_mov_b32 s34, 163840
  v_mul_lo_u32 v17, v17, s34
  s_and_b32 s34, s64, 7
  v_and_b32 v19, 7, v5
  v_xor_b32 v19, s34, v19
  v_lshl_add_u32 v17, v19, 5, v17
  v_lshrrev_b32 v19, 1, v6
  v_lshl_add_u32 v17, v19, 4, v17
  s_lshl_b32 s34, s64, 8
  s_add_u32 s34, s34, 5251072
  s_mov_b32 s35, 0xffff0000
  s_mov_b32 s41, 0x05040100
  s_mov_b32 s42, 0x07060302
  buffer_load_dwordx4 v[56:59], v4, s[12:15], 0 offen offset:0 nt
  buffer_load_dwordx4 v[60:63], v4, s[12:15], 0 offen offset:1024 nt
  buffer_load_dwordx4 v[64:67], v4, s[12:15], 0 offen offset:2048 nt
  buffer_load_dwordx4 v[68:71], v4, s[12:15], 0 offen offset:3072 nt
  s_waitcnt vmcnt(21)
  v_perm_b32 v156, v96, v100, s41
  v_perm_b32 v157, v96, v100, s42
  v_perm_b32 v158, v97, v101, s41
  v_perm_b32 v159, v97, v101, s42
  v_perm_b32 v160, v98, v102, s41
  v_perm_b32 v161, v98, v102, s42
  v_perm_b32 v162, v99, v103, s41
  v_perm_b32 v163, v99, v103, s42
  s_waitcnt vmcnt(20)
  v_perm_b32 v164, v100, v104, s41
  v_perm_b32 v165, v100, v104, s42
  v_perm_b32 v166, v101, v105, s41
  v_perm_b32 v167, v101, v105, s42
  v_perm_b32 v168, v102, v106, s41
  v_perm_b32 v169, v102, v106, s42
  v_perm_b32 v170, v103, v107, s41
  v_perm_b32 v171, v103, v107, s42
  s_waitcnt vmcnt(19)
  v_perm_b32 v172, v104, v108, s41
  v_perm_b32 v173, v104, v108, s42
  v_perm_b32 v174, v105, v109, s41
  v_perm_b32 v175, v105, v109, s42
  v_perm_b32 v176, v106, v110, s41
  v_perm_b32 v177, v106, v110, s42
  v_perm_b32 v178, v107, v111, s41
  v_perm_b32 v179, v107, v111, s42
  s_waitcnt vmcnt(18)
  v_perm_b32 v180, v108, v112, s41
  v_perm_b32 v181, v108, v112, s42
  v_perm_b32 v182, v109, v113, s41
  v_perm_b32 v183, v109, v113, s42
  v_perm_b32 v184, v110, v114, s41
  v_perm_b32 v185, v110, v114, s42
  v_perm_b32 v186, v111, v115, s41
  v_perm_b32 v187, v111, v115, s42
  s_waitcnt vmcnt(17)
  v_perm_b32 v188, v112, v116, s41
  v_perm_b32 v189, v112, v116, s42
  v_perm_b32 v190, v113, v117, s41
  v_perm_b32 v191, v113, v117, s42
  v_perm_b32 v192, v114, v118, s41
  v_perm_b32 v193, v114, v118, s42
  v_perm_b32 v194, v115, v119, s41
  v_perm_b32 v195, v115, v119, s42
  s_waitcnt vmcnt(16)
  v_perm_b32 v196, v116, v120, s41
  v_perm_b32 v197, v116, v120, s42
  v_perm_b32 v198, v117, v121, s41
  v_perm_b32 v199, v117, v121, s42
  v_perm_b32 v200, v118, v122, s41
  v_perm_b32 v201, v118, v122, s42
  v_perm_b32 v202, v119, v123, s41
  v_perm_b32 v203, v119, v123, s42
  s_waitcnt lgkmcnt(0)
  s_mul_i32 s45, s45, 0x9e3779b1
  s_add_u32 s45, s45, 0x7f4a7c15
  v_mov_b32 v243, s45
  s_waitcnt vmcnt(15)
  v_dot2_f32_bf16 v204, v172, v140, 0
  v_dot2_f32_bf16 v205, v173, v142, 0
  s_waitcnt vmcnt(14)
  v_dot2_f32_bf16 v206, v174, v144, 0
  v_dot2_f32_bf16 v207, v175, v146, 0
  s_waitcnt vmcnt(13)
  v_dot2_f32_bf16 v208, v176, v148, 0
  v_dot2_f32_bf16 v209, v177, v150, 0
  s_waitcnt vmcnt(12)
  v_dot2_f32_bf16 v210, v178, v152, 0
  v_dot2_f32_bf16 v211, v179, v154, 0
  v_dot2_f32_bf16 v212, v180, v140, 0
  v_dot2_f32_bf16 v213, v181, v142, 0
  v_dot2_f32_bf16 v214, v182, v144, 0
  v_dot2_f32_bf16 v215, v183, v146, 0
  v_dot2_f32_bf16 v216, v184, v148, 0
  v_dot2_f32_bf16 v217, v185, v150, 0
  v_dot2_f32_bf16 v218, v186, v152, 0
  v_dot2_f32_bf16 v219, v187, v154, 0
  v_dot2_f32_bf16 v220, v188, v140, 0
  v_dot2_f32_bf16 v221, v189, v142, 0
  v_dot2_f32_bf16 v222, v190, v144, 0
  v_dot2_f32_bf16 v223, v191, v146, 0
  v_dot2_f32_bf16 v224, v192, v148, 0
  v_dot2_f32_bf16 v225, v193, v150, 0
  v_dot2_f32_bf16 v226, v194, v152, 0
  v_dot2_f32_bf16 v227, v195, v154, 0
  v_dot2_f32_bf16 v228, v196, v140, 0
  v_dot2_f32_bf16 v229, v197, v142, 0
  v_dot2_f32_bf16 v230, v198, v144, 0
  v_dot2_f32_bf16 v231, v199, v146, 0
  v_dot2_f32_bf16 v232, v200, v148, 0
  v_dot2_f32_bf16 v233, v201, v150, 0
  v_dot2_f32_bf16 v234, v202, v152, 0
  v_dot2_f32_bf16 v235, v203, v154, 0
  v_dot2c_f32_bf16 v204, v156, v141
  v_dot2c_f32_bf16 v205, v157, v143
  v_dot2c_f32_bf16 v206, v158, v145
  v_dot2c_f32_bf16 v207, v159, v147
  v_dot2c_f32_bf16 v208, v160, v149
  v_dot2c_f32_bf16 v209, v161, v151
  v_dot2c_f32_bf16 v210, v162, v153
  v_dot2c_f32_bf16 v211, v163, v155
  v_dot2c_f32_bf16 v212, v164, v141
  v_dot2c_f32_bf16 v213, v165, v143
  v_dot2c_f32_bf16 v214, v166, v145
  v_dot2c_f32_bf16 v215, v167, v147
  v_dot2c_f32_bf16 v216, v168, v149
  v_dot2c_f32_bf16 v217, v169, v151
  v_dot2c_f32_bf16 v218, v170, v153
  v_dot2c_f32_bf16 v219, v171, v155
  v_dot2c_f32_bf16 v220, v172, v141
  v_dot2c_f32_bf16 v221, v173, v143
  v_dot2c_f32_bf16 v222, v174, v145
  v_dot2c_f32_bf16 v223, v175, v147
  v_dot2c_f32_bf16 v224, v176, v149
  v_dot2c_f32_bf16 v225, v177, v151
  v_dot2c_f32_bf16 v226, v178, v153
  v_dot2c_f32_bf16 v227, v179, v155
  v_dot2c_f32_bf16 v228, v180, v141
  v_dot2c_f32_bf16 v229, v181, v143
  v_dot2c_f32_bf16 v230, v182, v145
  v_dot2c_f32_bf16 v231, v183, v147
  v_dot2c_f32_bf16 v232, v184, v149
  v_dot2c_f32_bf16 v233, v185, v151
  v_dot2c_f32_bf16 v234, v186, v153
  v_dot2c_f32_bf16 v235, v187, v155
  s_waitcnt vmcnt(8)
  s_barrier
  s_mov_b64 exec, 1
  buffer_store_dword v243, v240, s[20:23], s72 offen sc1
  s_mov_b64 exec, -1
  s_waitcnt vmcnt(8)
  v_lshlrev_b32 v156, 16, v124
  v_and_b32 v157, s35, v124
  v_lshlrev_b32 v158, 16, v125
  v_and_b32 v159, s35, v125
  v_lshlrev_b32 v160, 16, v126
  v_and_b32 v161, s35, v126
  v_lshlrev_b32 v162, 16, v127
  v_and_b32 v163, s35, v127
  s_waitcnt vmcnt(7)
  v_lshlrev_b32 v164, 16, v128
  v_and_b32 v165, s35, v128
  v_lshlrev_b32 v166, 16, v129
  v_and_b32 v167, s35, v129
  v_lshlrev_b32 v168, 16, v130
  v_and_b32 v169, s35, v130
  v_lshlrev_b32 v170, 16, v131
  v_and_b32 v171, s35, v131
  s_waitcnt vmcnt(6)
  v_lshlrev_b32 v172, 16, v132
  v_and_b32 v173, s35, v132
  v_lshlrev_b32 v174, 16, v133
  v_and_b32 v175, s35, v133
  v_lshlrev_b32 v176, 16, v134
  v_and_b32 v177, s35, v134
  v_lshlrev_b32 v178, 16, v135
  v_and_b32 v179, s35, v135
  s_waitcnt vmcnt(5)
  v_lshlrev_b32 v180, 16, v136
  v_and_b32 v181, s35, v136
  v_lshlrev_b32 v182, 16, v137
  v_and_b32 v183, s35, v137
  v_lshlrev_b32 v184, 16, v138
  v_and_b32 v185, s35, v138
  v_lshlrev_b32 v186, 16, v139
  v_and_b32 v187, s35, v139
  v_mul_f32 v204, v204, v156
  v_mul_f32 v212, v212, v164
  v_mul_f32 v220, v220, v172
  v_mul_f32 v228, v228, v180
  v_cvt_pk_bf16_f32 v96, v228, v220
  v_cvt_pk_bf16_f32 v97, v212, v204
  ds_write_b64 v9, v[96:97] offset:0
  v_mul_f32 v205, v205, v157
  v_mul_f32 v213, v213, v165
  v_mul_f32 v221, v221, v173
  v_mul_f32 v229, v229, v181
  v_cvt_pk_bf16_f32 v98, v229, v221
  v_cvt_pk_bf16_f32 v99, v213, v205
  ds_write_b64 v9, v[98:99] offset:128
  v_mul_f32 v206, v206, v158
  v_mul_f32 v214, v214, v166
  v_mul_f32 v222, v222, v174
  v_mul_f32 v230, v230, v182
  v_cvt_pk_bf16_f32 v100, v230, v222
  v_cvt_pk_bf16_f32 v101, v214, v206
  ds_write_b64 v9, v[100:101] offset:256
  v_mul_f32 v207, v207, v159
  v_mul_f32 v215, v215, v167
  v_mul_f32 v223, v223, v175
  v_mul_f32 v231, v231, v183
  v_cvt_pk_bf16_f32 v102, v231, v223
  v_cvt_pk_bf16_f32 v103, v215, v207
  ds_write_b64 v9, v[102:103] offset:384
  v_mul_f32 v208, v208, v160
  v_mul_f32 v216, v216, v168
  v_mul_f32 v224, v224, v176
  v_mul_f32 v232, v232, v184
  v_cvt_pk_bf16_f32 v104, v232, v224
  v_cvt_pk_bf16_f32 v105, v216, v208
  ds_write_b64 v9, v[104:105] offset:512
  v_mul_f32 v209, v209, v161
  v_mul_f32 v217, v217, v169
  v_mul_f32 v225, v225, v177
  v_mul_f32 v233, v233, v185
  v_cvt_pk_bf16_f32 v106, v233, v225
  v_cvt_pk_bf16_f32 v107, v217, v209
  ds_write_b64 v9, v[106:107] offset:640
  v_mul_f32 v210, v210, v162
  v_mul_f32 v218, v218, v170
  v_mul_f32 v226, v226, v178
  v_mul_f32 v234, v234, v186
  v_cvt_pk_bf16_f32 v108, v234, v226
  v_cvt_pk_bf16_f32 v109, v218, v210
  ds_write_b64 v9, v[108:109] offset:768
  v_mul_f32 v211, v211, v163
  v_mul_f32 v219, v219, v171
  v_mul_f32 v227, v227, v179
  v_mul_f32 v235, v235, v187
  v_cvt_pk_bf16_f32 v110, v235, v227
  v_cvt_pk_bf16_f32 v111, v219, v211
  ds_write_b64 v9, v[110:111] offset:896
  s_waitcnt lgkmcnt(0)
  s_barrier
  ds_read_b128 v[124:127], v8 offset:0
  ds_read_b128 v[128:131], v8 offset:1024
  ds_read_b128 v[132:135], v8 offset:2048
  ds_read_b128 v[136:139], v8 offset:3072
  buffer_load_dword v19, v18, s[20:23], s73 offen sc1
  s_waitcnt lgkmcnt(3)
  buffer_store_dwordx4 v[124:127], v244, s[20:23], s71 offen sc1
  s_waitcnt lgkmcnt(2)
  buffer_store_dwordx4 v[128:131], v245, s[20:23], s71 offen sc1
  s_waitcnt lgkmcnt(1)
  buffer_store_dwordx4 v[132:135], v246, s[20:23], s71 offen sc1
  s_waitcnt lgkmcnt(0)
  buffer_store_dwordx4 v[136:139], v247, s[20:23], s71 offen sc1
  v_mov_b32 v72, 0
  s_waitcnt vmcnt(9)
  ds_write_b128 v10, v[56:59] offset:32
  v_mov_b32_dpp v73, v59 wave_ror:1 row_mask:0xf bank_mask:0xf
  v_mov_b32_dpp v72, v59 wave_shr:1 row_mask:0xf bank_mask:0xf
  v_alignbit_b32 v81, v57, v56, 16
  v_alignbit_b32 v82, v58, v57, 16
  v_alignbit_b32 v83, v59, v58, 16
  v_alignbit_b32 v80, v56, v72, 16
  ds_write_b128 v10, v[80:83] offset:4192
  s_waitcnt vmcnt(8)
  ds_write_b128 v10, v[60:63] offset:1056
  v_mov_b32_dpp v74, v63 wave_ror:1 row_mask:0xf bank_mask:0xf
  v_mov_b32_dpp v73, v63 wave_shr:1 row_mask:0xf bank_mask:0xf
  v_alignbit_b32 v85, v61, v60, 16
  v_alignbit_b32 v86, v62, v61, 16
  v_alignbit_b32 v87, v63, v62, 16
  v_alignbit_b32 v84, v60, v73, 16
  ds_write_b128 v10, v[84:87] offset:5216
  s_waitcnt vmcnt(7)
  ds_write_b128 v10, v[64:67] offset:2080
  v_mov_b32_dpp v75, v67 wave_ror:1 row_mask:0xf bank_mask:0xf
  v_mov_b32_dpp v74, v67 wave_shr:1 row_mask:0xf bank_mask:0xf
  v_alignbit_b32 v89, v65, v64, 16
  v_alignbit_b32 v90, v66, v65, 16
  v_alignbit_b32 v91, v67, v66, 16
  v_alignbit_b32 v88, v64, v74, 16
  ds_write_b128 v10, v[88:91] offset:6240
  s_waitcnt vmcnt(6)
  ds_write_b128 v10, v[68:71] offset:3104
  v_mov_b32_dpp v75, v71 wave_shr:1 row_mask:0xf bank_mask:0xf
  v_alignbit_b32 v93, v69, v68, 16
  v_alignbit_b32 v94, v70, v69, 16
  v_alignbit_b32 v95, v71, v70, 16
  v_alignbit_b32 v92, v68, v75, 16
  ds_write_b128 v10, v[92:95] offset:7264
  v_lshlrev_b32 v3, 3, v6
  v_add_u32 v3, v3, v5
  v_sub_u32 v3, 15, v3
  s_and_b32 s28, s64, 1
  s_lshl_b32 s28, s28, 4
  s_lshr_b32 s29, s29, s28
  s_and_b32 s29, s29, 0xffff
  v_and_b32 v239, 1, v3
  v_lshlrev_b32 v239, 4, v239
  v_lshlrev_b32 v239, v239, s29
  v_lshrrev_b32 v3, 1, v3
  v_cmp_eq_u32 vcc, 0, v3
  s_nop 1
  v_cndmask_b32 v20, 0, v239, vcc
  v_cmp_eq_u32 vcc, 1, v3
  s_nop 1
  v_cndmask_b32 v21, 0, v239, vcc
  v_cmp_eq_u32 vcc, 2, v3
  s_nop 1
  v_cndmask_b32 v22, 0, v239, vcc
  v_cmp_eq_u32 vcc, 3, v3
  s_nop 1
  v_cndmask_b32 v23, 0, v239, vcc
  s_waitcnt vmcnt(4)
  v_cmp_eq_u32 vcc, s45, v19
  s_nop 1
  s_or_b64 vcc, vcc, s[50:51]
  s_cmp_eq_u64 vcc, -1
  s_cbranch_scc0 L1_fs
L1_fb:
  s_barrier
  buffer_load_dwordx4 v[184:187], v4, s[20:23], s67 offen offset:3072 sc1
  buffer_load_dwordx4 v[188:191], v4, s[20:23], s67 offen offset:2048 sc1
  buffer_load_dwordx4 v[192:195], v4, s[20:23], s67 offen offset:1024 sc1
  buffer_load_dwordx4 v[196:199], v4, s[20:23], s67 offen offset:0 sc1
  s_mov_b64 exec, 1
  buffer_store_dword v243, v241, s[20:23], s46 offen
  s_mov_b64 exec, -1
  v_mov_b32 v18, v242
  ds_read2_b32 a[0:1], v12 offset0:0 offset1:1
  ds_read2_b32 a[2:3], v12 offset0:2 offset1:3
  ds_read2_b32 a[4:5], v12 offset0:128 offset1:129
  ds_read2_b32 a[6:7], v12 offset0:130 offset1:131
  ds_read2_b32 a[8:9], v13 offset0:0 offset1:1
  ds_read2_b32 a[10:11], v13 offset0:2 offset1:3
  ds_read2_b32 a[12:13], v13 offset0:128 offset1:129
  ds_read2_b32 a[14:15], v13 offset0:130 offset1:131
  ds_read2_b32 a[16:17], v14 offset0:0 offset1:1
  ds_read2_b32 a[18:19], v14 offset0:2 offset1:3
  ds_read2_b32 a[20:21], v14 offset0:128 offset1:129
  ds_read2_b32 a[22:23], v14 offset0:130 offset1:131
  ds_read2_b32 a[24:25], v15 offset0:0 offset1:1
  ds_read2_b32 a[26:27], v15 offset0:2 offset1:3
  ds_read2_b32 a[28:29], v15 offset0:128 offset1:129
  ds_read2_b32 a[30:31], v15 offset0:130 offset1:131
  ds_read2_b32 a[32:33], v12 offset0:16 offset1:17
  ds_read2_b32 a[34:35], v12 offset0:18 offset1:19
  ds_read2_b32 a[36:37], v12 offset0:144 offset1:145
  ds_read2_b32 a[38:39], v12 offset0:146 offset1:147
  ds_read2_b32 a[40:41], v13 offset0:16 offset1:17
  ds_read2_b32 a[42:43], v13 offset0:18 offset1:19
  ds_read2_b32 a[44:45], v13 offset0:144 offset1:145
  ds_read2_b32 a[46:47], v13 offset0:146 offset1:147
  ds_read2_b32 a[48:49], v14 offset0:16 offset1:17
  ds_read2_b32 a[50:51], v14 offset0:18 offset1:19
  ds_read2_b32 a[52:53], v14 offset0:144 offset1:145
  ds_read2_b32 a[54:55], v14 offset0:146 offset1:147
  ds_read2_b32 a[56:57], v15 offset0:16 offset1:17
  ds_read2_b32 a[58:59], v15 offset0:18 offset1:19
  ds_read2_b32 a[60:61], v15 offset0:144 offset1:145
  ds_read2_b32 a[62:63], v15 offset0:146 offset1:147
  ds_read2_b32 a[64:65], v12 offset0:32 offset1:33
  ds_read2_b32 a[66:67], v12 offset0:34 offset1:35
  ds_read2_b32 a[68:69], v12 offset0:160 offset1:161
  ds_read2_b32 a[70:71], v12 offset0:162 offset1:163
  ds_read2_b32 a[72:73], v13 offset0:32 offset1:33
  ds_read2_b32 a[74:75], v13 offset0:34 offset1:35
  ds_read2_b32 a[76:77], v13 offset0:160 offset1:161
  ds_read2_b32 a[78:79], v13 offset0:162 offset1:163
  ds_read2_b32 a[80:81], v14 offset0:32 offset1:33
  ds_read2_b32 a[82:83], v14 offset0:34 offset1:35
  ds_read2_b32 a[84:85], v14 offset0:160 offset1:161
  ds_read2_b32 a[86:87], v14 offset0:162 offset1:163
  ds_read2_b32 a[88:89], v15 offset0:32 offset1:33
  ds_read2_b32 a[90:91], v15 offset0:34 offset1:35
  ds_read2_b32 a[92:93], v15 offset0:160 offset1:161
  ds_read2_b32 a[94:95], v15 offset0:162 offset1:163
  ds_read2_b32 a[96:97], v12 offset0:48 offset1:49
  ds_read2_b32 a[98:99], v12 offset0:50 offset1:51
  ds_read2_b32 a[100:101], v12 offset0:176 offset1:177
  ds_read2_b32 a[102:103], v12 offset0:178 offset1:179
  ds_read2_b32 a[104:105], v13 offset0:48 offset1:49
  ds_read2_b32 a[106:107], v13 offset0:50 offset1:51
  ds_read2_b32 a[108:109], v13 offset0:176 offset1:177
  ds_read2_b32 a[110:111], v13 offset0:178 offset1:179
  ds_read2_b32 a[112:113], v14 offset0:48 offset1:49
  ds_read2_b32 a[114:115], v14 offset0:50 offset1:51
  ds_read2_b32 a[116:117], v14 offset0:176 offset1:177
  ds_read2_b32 a[118:119], v14 offset0:178 offset1:179
  ds_read2_b32 a[120:121], v15 offset0:48 offset1:49
  ds_read2_b32 a[122:123], v15 offset0:50 offset1:51
  ds_read2_b32 a[124:125], v15 offset0:176 offset1:177
  ds_read2_b32 a[126:127], v15 offset0:178 offset1:179
  s_waitcnt vmcnt(4)
  v_max3_u32 v3, v184, v185, v186
  v_max_u32 v3, v3, v187
  v_cmp_eq_u32 vcc, -1, v3
  s_nop 1
  s_cbranch_vccnz L1_ks0
L1_kb0:
  ds_write_b128 v10, v[184:187] offset:11392
  ds_read_b128 v[56:59], v11 offset:3584
  ds_read_b128 v[60:63], v11 offset:3072
  ds_read_b128 v[64:67], v11 offset:3648
  ds_read_b128 v[68:71], v11 offset:3136
  s_waitcnt lgkmcnt(3)
  v_mfma_f32_16x16x32_bf16 v[24:27], v[20:23], v[56:59], 0
  ds_read_b128 v[72:75], v11 offset:3712
  ds_read_b128 v[76:79], v11 offset:3200
  v_mfma_f32_16x16x32_bf16 v[24:27], a[0:3], v[56:59], v[24:27]
  ds_read2_b32 a[128:129], v12 offset0:64 offset1:65
  v_mfma_f32_16x16x32_bf16 v[28:31], a[4:7], v[56:59], 0
  ds_read2_b32 a[130:131], v12 offset0:66 offset1:67
  v_mfma_f32_16x16x32_bf16 v[32:35], a[8:11], v[56:59], 0
  ds_read2_b32 a[132:133], v12 offset0:192 offset1:193
  v_mfma_f32_16x16x32_bf16 v[36:39], a[12:15], v[56:59], 0
  ds_read2_b32 a[134:135], v12 offset0:194 offset1:195
  v_mfma_f32_16x16x32_bf16 v[40:43], a[16:19], v[56:59], 0
  ds_read2_b32 a[136:137], v13 offset0:64 offset1:65
  ds_read2_b32 a[138:139], v13 offset0:66 offset1:67
  s_and_b32 s53, s53, 0xffff
  buffer_load_dword v237, v237, s[52:55], 0 offen
  v_mfma_f32_16x16x32_bf16 v[44:47], a[20:23], v[56:59], 0
  ds_read2_b32 a[140:141], v13 offset0:192 offset1:193
  v_mfma_f32_16x16x32_bf16 v[48:51], a[24:27], v[56:59], 0
  ds_read2_b32 a[142:143], v13 offset0:194 offset1:195
  v_mfma_f32_16x16x32_bf16 v[52:55], a[28:31], v[56:59], 0
  ds_read2_b32 a[144:145], v14 offset0:64 offset1:65
  s_waitcnt lgkmcnt(13)
  v_mfma_f32_16x16x32_bf16 v[28:31], v[20:23], v[60:63], v[28:31]
  ds_read2_b32 a[146:147], v14 offset0:66 offset1:67
  v_mfma_f32_16x16x32_bf16 v[28:31], a[0:3], v[60:63], v[28:31]
  ds_read2_b32 a[148:149], v14 offset0:192 offset1:193
  ds_read2_b32 a[150:151], v14 offset0:194 offset1:195
  v_mfma_f32_16x16x32_bf16 v[32:35], a[4:7], v[60:63], v[32:35]
  ds_read2_b32 a[152:153], v15 offset0:64 offset1:65
  v_mfma_f32_16x16x32_bf16 v[36:39], a[8:11], v[60:63], v[36:39]
  ds_read2_b32 a[154:155], v15 offset0:66 offset1:67
  v_mfma_f32_16x16x32_bf16 v[40:43], a[12:15], v[60:63], v[40:43]
  ds_read2_b32 a[156:157], v15 offset0:192 offset1:193
  v_mfma_f32_16x16x32_bf16 v[44:47], a[16:19], v[60:63], v[44:47]
  ds_read2_b32 a[158:159], v15 offset0:194 offset1:195
  v_mfma_f32_16x16x32_bf16 v[48:51], a[20:23], v[60:63], v[48:51]
  ds_read_b128 v[80:83], v11 offset:3776
  ds_read_b128 v[84:87], v11 offset:3264
  v_mfma_f32_16x16x32_bf16 v[52:55], a[24:27], v[60:63], v[52:55]
  ds_read2_b32 a[160:161], v12 offset0:80 offset1:81
  s_waitcnt lgkmcnt(15)
  v_mfma_f32_16x16x32_bf16 v[24:27], a[32:35], v[64:67], v[24:27]
  ds_read2_b32 a[162:163], v12 offset0:82 offset1:83
  v_mfma_f32_16x16x32_bf16 v[28:31], a[36:39], v[64:67], v[28:31]
  ds_read2_b32 a[164:165], v12 offset0:208 offset1:209
  v_mfma_f32_16x16x32_bf16 v[32:35], a[40:43], v[64:67], v[32:35]
  ds_read2_b32 a[166:167], v12 offset0:210 offset1:211
  v_mfma_f32_16x16x32_bf16 v[36:39], a[44:47], v[64:67], v[36:39]
  ds_read2_b32 a[168:169], v13 offset0:80 offset1:81
  ds_read2_b32 a[170:171], v13 offset0:82 offset1:83
  v_mfma_f32_16x16x32_bf16 v[40:43], a[48:51], v[64:67], v[40:43]
  ds_read2_b32 a[172:173], v13 offset0:208 offset1:209
  v_mfma_f32_16x16x32_bf16 v[44:47], a[52:55], v[64:67], v[44:47]
  ds_read2_b32 a[174:175], v13 offset0:210 offset1:211
  v_mfma_f32_16x16x32_bf16 v[48:51], a[56:59], v[64:67], v[48:51]
  ds_read2_b32 a[176:177], v14 offset0:80 offset1:81
  v_mfma_f32_16x16x32_bf16 v[52:55], a[60:63], v[64:67], v[52:55]
  ds_read2_b32 a[178:179], v14 offset0:82 offset1:83
  v_mfma_f32_16x16x32_bf16 v[28:31], a[32:35], v[68:71], v[28:31]
  ds_read2_b32 a[180:181], v14 offset0:208 offset1:209
  ds_read2_b32 a[182:183], v14 offset0:210 offset1:211
  v_mfma_f32_16x16x32_bf16 v[32:35], a[36:39], v[68:71], v[32:35]
  ds_read2_b32 a[184:185], v15 offset0:80 offset1:81
  v_mfma_f32_16x16x32_bf16 v[36:39], a[40:43], v[68:71], v[36:39]
  ds_read2_b32 a[186:187], v15 offset0:82 offset1:83
  v_mfma_f32_16x16x32_bf16 v[40:43], a[44:47], v[68:71], v[40:43]
  ds_read2_b32 a[188:189], v15 offset0:208 offset1:209
  v_mfma_f32_16x16x32_bf16 v[44:47], a[48:51], v[68:71], v[44:47]
  ds_read2_b32 a[190:191], v15 offset0:210 offset1:211
  v_mfma_f32_16x16x32_bf16 v[48:51], a[52:55], v[68:71], v[48:51]
  ds_read_b128 v[88:91], v11 offset:3840
  ds_read_b128 v[92:95], v11 offset:3328
  v_mfma_f32_16x16x32_bf16 v[52:55], a[56:59], v[68:71], v[52:55]
  ds_read2_b32 a[192:193], v12 offset0:96 offset1:97
  v_mfma_f32_16x16x32_bf16 v[24:27], a[64:67], v[72:75], v[24:27]
  ds_read2_b32 a[194:195], v12 offset0:98 offset1:99
  v_mfma_f32_16x16x32_bf16 v[28:31], a[68:71], v[72:75], v[28:31]
  ds_read2_b32 a[196:197], v12 offset0:224 offset1:225
  v_mfma_f32_16x16x32_bf16 v[32:35], a[72:75], v[72:75], v[32:35]
  ds_read2_b32 a[198:199], v12 offset0:226 offset1:227
  v_mfma_f32_16x16x32_bf16 v[36:39], a[76:79], v[72:75], v[36:39]
  ds_read2_b32 a[200:201], v13 offset0:96 offset1:97
  ds_read2_b32 a[202:203], v13 offset0:98 offset1:99
  v_mfma_f32_16x16x32_bf16 v[40:43], a[80:83], v[72:75], v[40:43]
  ds_read2_b32 a[204:205], v13 offset0:224 offset1:225
  v_mfma_f32_16x16x32_bf16 v[44:47], a[84:87], v[72:75], v[44:47]
  ds_read2_b32 a[206:207], v13 offset0:226 offset1:227
  v_mfma_f32_16x16x32_bf16 v[48:51], a[88:91], v[72:75], v[48:51]
  ds_read2_b32 a[208:209], v14 offset0:96 offset1:97
  v_mfma_f32_16x16x32_bf16 v[52:55], a[92:95], v[72:75], v[52:55]
  ds_read2_b32 a[210:211], v14 offset0:98 offset1:99
  v_mfma_f32_16x16x32_bf16 v[28:31], a[64:67], v[76:79], v[28:31]
  ds_read2_b32 a[212:213], v14 offset0:224 offset1:225
  ds_read2_b32 a[214:215], v14 offset0:226 offset1:227
  v_mfma_f32_16x16x32_bf16 v[32:35], a[68:71], v[76:79], v[32:35]
  ds_read2_b32 a[216:217], v15 offset0:96 offset1:97
  v_mfma_f32_16x16x32_bf16 v[36:39], a[72:75], v[76:79], v[36:39]
  ds_read2_b32 a[218:219], v15 offset0:98 offset1:99
  v_mfma_f32_16x16x32_bf16 v[40:43], a[76:79], v[76:79], v[40:43]
  ds_read2_b32 a[220:221], v15 offset0:224 offset1:225
  v_mfma_f32_16x16x32_bf16 v[44:47], a[80:83], v[76:79], v[44:47]
  ds_read2_b32 a[222:223], v15 offset0:226 offset1:227
  v_mfma_f32_16x16x32_bf16 v[48:51], a[84:87], v[76:79], v[48:51]
  ds_read_b128 v[96:99], v11 offset:3904
  ds_read_b128 v[100:103], v11 offset:3392
  v_mfma_f32_16x16x32_bf16 v[52:55], a[88:91], v[76:79], v[52:55]
  ds_read2_b32 a[224:225], v12 offset0:112 offset1:113
  s_waitcnt lgkmcnt(15)
  v_mfma_f32_16x16x32_bf16 v[24:27], a[96:99], v[80:83], v[24:27]
  ds_read2_b32 a[226:227], v12 offset0:114 offset1:115
  v_mfma_f32_16x16x32_bf16 v[28:31], a[100:103], v[80:83], v[28:31]
  ds_read2_b32 a[228:229], v12 offset0:240 offset1:241
  v_mfma_f32_16x16x32_bf16 v[32:35], a[104:107], v[80:83], v[32:35]
  ds_read2_b32 a[230:231], v12 offset0:242 offset1:243
  v_mfma_f32_16x16x32_bf16 v[36:39], a[108:111], v[80:83], v[36:39]
  ds_read2_b32 a[232:233], v13 offset0:112 offset1:113
  ds_read2_b32 a[234:235], v13 offset0:114 offset1:115
  v_mfma_f32_16x16x32_bf16 v[40:43], a[112:115], v[80:83], v[40:43]
  ds_read2_b32 a[236:237], v13 offset0:240 offset1:241
  v_mfma_f32_16x16x32_bf16 v[44:47], a[116:119], v[80:83], v[44:47]
  ds_read2_b32 a[238:239], v13 offset0:242 offset1:243
  v_mfma_f32_16x16x32_bf16 v[48:51], a[120:123], v[80:83], v[48:51]
  ds_read2_b32 a[240:241], v14 offset0:112 offset1:113
  v_mfma_f32_16x16x32_bf16 v[52:55], a[124:127], v[80:83], v[52:55]
  ds_read2_b32 a[242:243], v14 offset0:114 offset1:115
  v_mfma_f32_16x16x32_bf16 v[28:31], a[96:99], v[84:87], v[28:31]
  ds_read2_b32 a[244:245], v14 offset0:240 offset1:241
  ds_read2_b32 a[246:247], v14 offset0:242 offset1:243
  v_mfma_f32_16x16x32_bf16 v[32:35], a[100:103], v[84:87], v[32:35]
  ds_read2_b32 a[248:249], v15 offset0:112 offset1:113
  v_mfma_f32_16x16x32_bf16 v[36:39], a[104:107], v[84:87], v[36:39]
  ds_read2_b32 a[250:251], v15 offset0:114 offset1:115
  v_mfma_f32_16x16x32_bf16 v[40:43], a[108:111], v[84:87], v[40:43]
  ds_read2_b32 a[252:253], v15 offset0:240 offset1:241
  v_mfma_f32_16x16x32_bf16 v[44:47], a[112:115], v[84:87], v[44:47]
  ds_read2_b32 a[254:255], v15 offset0:242 offset1:243
  v_mfma_f32_16x16x32_bf16 v[48:51], a[116:119], v[84:87], v[48:51]
  ds_read_b128 v[104:107], v11 offset:3968
  v_mfma_f32_16x16x32_bf16 v[52:55], a[120:123], v[84:87], v[52:55]
  ds_read_b128 v[108:111], v11 offset:3456
  v_mfma_f32_16x16x32_bf16 v[24:27], a[128:131], v[88:91], v[24:27]
  v_mfma_f32_16x16x32_bf16 v[28:31], a[132:135], v[88:91], v[28:31]
  v_mfma_f32_16x16x32_bf16 v[32:35], a[136:139], v[88:91], v[32:35]
  v_mfma_f32_16x16x32_bf16 v[36:39], a[140:143], v[88:91], v[36:39]
  v_mfma_f32_16x16x32_bf16 v[40:43], a[144:147], v[88:91], v[40:43]
  v_mfma_f32_16x16x32_bf16 v[44:47], a[148:151], v[88:91], v[44:47]
  v_mfma_f32_16x16x32_bf16 v[48:51], a[152:155], v[88:91], v[48:51]
  v_mfma_f32_16x16x32_bf16 v[52:55], a[156:159], v[88:91], v[52:55]
  v_mfma_f32_16x16x32_bf16 v[28:31], a[128:131], v[92:95], v[28:31]
  v_mfma_f32_16x16x32_bf16 v[32:35], a[132:135], v[92:95], v[32:35]
  v_mfma_f32_16x16x32_bf16 v[36:39], a[136:139], v[92:95], v[36:39]
  v_mfma_f32_16x16x32_bf16 v[40:43], a[140:143], v[92:95], v[40:43]
  v_mfma_f32_16x16x32_bf16 v[44:47], a[144:147], v[92:95], v[44:47]
  v_mfma_f32_16x16x32_bf16 v[48:51], a[148:151], v[92:95], v[48:51]
  ds_read_b128 v[112:115], v11 offset:4032
  v_mfma_f32_16x16x32_bf16 v[52:55], a[152:155], v[92:95], v[52:55]
  ds_read_b128 v[116:119], v11 offset:3520
  s_waitcnt lgkmcnt(15)
  v_mfma_f32_16x16x32_bf16 v[24:27], a[160:163], v[96:99], v[24:27]
  v_mfma_f32_16x16x32_bf16 v[28:31], a[164:167], v[96:99], v[28:31]
  v_mfma_f32_16x16x32_bf16 v[32:35], a[168:171], v[96:99], v[32:35]
  v_mfma_f32_16x16x32_bf16 v[36:39], a[172:175], v[96:99], v[36:39]
  v_mfma_f32_16x16x32_bf16 v[40:43], a[176:179], v[96:99], v[40:43]
  v_mfma_f32_16x16x32_bf16 v[44:47], a[180:183], v[96:99], v[44:47]
  s_waitcnt vmcnt(4)
  v_max3_u32 v3, v188, v189, v190
  v_max_u32 v3, v3, v191
  v_cmp_eq_u32 vcc, -1, v3
  s_nop 1
  s_cbranch_vccnz L1_ks1
L1_kb1:
  ds_write_b128 v10, v[188:191] offset:10368
  v_mfma_f32_16x16x32_bf16 v[48:51], a[184:187], v[96:99], v[48:51]
  v_mfma_f32_16x16x32_bf16 v[52:55], a[188:191], v[96:99], v[52:55]
  ds_read_b128 v[120:123], v11 offset:2560
  v_mfma_f32_16x16x32_bf16 v[28:31], a[160:163], v[100:103], v[28:31]
  ds_read_b128 v[124:127], v11 offset:2048
  v_mfma_f32_16x16x32_bf16 v[32:35], a[164:167], v[100:103], v[32:35]
  ds_read_b128 v[128:131], v11 offset:2624
  v_mfma_f32_16x16x32_bf16 v[36:39], a[168:171], v[100:103], v[36:39]
  ds_read_b128 v[132:135], v11 offset:2112
  v_mfma_f32_16x16x32_bf16 v[40:43], a[172:175], v[100:103], v[40:43]
  ds_read_b128 v[136:139], v11 offset:2688
  v_mfma_f32_16x16x32_bf16 v[44:47], a[176:179], v[100:103], v[44:47]
  ds_read_b128 v[140:143], v11 offset:2176
  v_mfma_f32_16x16x32_bf16 v[48:51], a[180:183], v[100:103], v[48:51]
  ds_read_b128 v[144:147], v11 offset:2752
  v_mfma_f32_16x16x32_bf16 v[52:55], a[184:187], v[100:103], v[52:55]
  ds_read_b128 v[148:151], v11 offset:2240
  s_waitcnt lgkmcnt(12)
  v_mfma_f32_16x16x32_bf16 v[24:27], a[192:195], v[104:107], v[24:27]
  ds_read_b128 v[152:155], v11 offset:2816
  v_mfma_f32_16x16x32_bf16 v[28:31], a[196:199], v[104:107], v[28:31]
  ds_read_b128 v[156:159], v11 offset:2304
  v_mfma_f32_16x16x32_bf16 v[32:35], a[200:203], v[104:107], v[32:35]
  ds_read_b128 v[160:163], v11 offset:2880
  v_mfma_f32_16x16x32_bf16 v[36:39], a[204:207], v[104:107], v[36:39]
  ds_read_b128 v[164:167], v11 offset:2368
  v_mfma_f32_16x16x32_bf16 v[40:43], a[208:211], v[104:107], v[40:43]
  ds_read_b128 v[168:171], v11 offset:2944
  v_mfma_f32_16x16x32_bf16 v[44:47], a[212:215], v[104:107], v[44:47]
  ds_read_b128 v[172:175], v11 offset:2432
  v_mfma_f32_16x16x32_bf16 v[48:51], a[216:219], v[104:107], v[48:51]
  ds_read_b128 v[176:179], v11 offset:3008
  v_mfma_f32_16x16x32_bf16 v[52:55], a[220:223], v[104:107], v[52:55]
  ds_read_b128 v[180:183], v11 offset:2496
  s_waitcnt lgkmcnt(15)
  v_mfma_f32_16x16x32_bf16 v[28:31], a[192:195], v[108:111], v[28:31]
  v_mfma_f32_16x16x32_bf16 v[32:35], a[196:199], v[108:111], v[32:35]
  v_mfma_f32_16x16x32_bf16 v[36:39], a[200:203], v[108:111], v[36:39]
  v_mfma_f32_16x16x32_bf16 v[40:43], a[204:207], v[108:111], v[40:43]
  v_mfma_f32_16x16x32_bf16 v[44:47], a[208:211], v[108:111], v[44:47]
  v_mfma_f32_16x16x32_bf16 v[48:51], a[212:215], v[108:111], v[48:51]
  v_mfma_f32_16x16x32_bf16 v[52:55], a[216:219], v[108:111], v[52:55]
  v_mfma_f32_16x16x32_bf16 v[24:27], a[224:227], v[112:115], v[24:27]
  v_mfma_f32_16x16x32_bf16 v[28:31], a[228:231], v[112:115], v[28:31]
  v_mfma_f32_16x16x32_bf16 v[32:35], a[232:235], v[112:115], v[32:35]
  v_mfma_f32_16x16x32_bf16 v[36:39], a[236:239], v[112:115], v[36:39]
  v_mfma_f32_16x16x32_bf16 v[40:43], a[240:243], v[112:115], v[40:43]
  v_mfma_f32_16x16x32_bf16 v[44:47], a[244:247], v[112:115], v[44:47]
  v_mfma_f32_16x16x32_bf16 v[48:51], a[248:251], v[112:115], v[48:51]
  v_mfma_f32_16x16x32_bf16 v[52:55], a[252:255], v[112:115], v[52:55]
  v_mfma_f32_16x16x32_bf16 v[28:31], a[224:227], v[116:119], v[28:31]
  v_mfma_f32_16x16x32_bf16 v[32:35], a[228:231], v[116:119], v[32:35]
  v_mfma_f32_16x16x32_bf16 v[36:39], a[232:235], v[116:119], v[36:39]
  v_mfma_f32_16x16x32_bf16 v[40:43], a[236:239], v[116:119], v[40:43]
  v_mfma_f32_16x16x32_bf16 v[44:47], a[240:243], v[116:119], v[44:47]
  v_mfma_f32_16x16x32_bf16 v[48:51], a[244:247], v[116:119], v[48:51]
  buffer_load_dword v19, v18, s[16:19], 0 offen sc1
  v_mfma_f32_16x16x32_bf16 v[52:55], a[248:251], v[116:119], v[52:55]
  v_mfma_f32_16x16x32_bf16 v[32:35], v[20:23], v[120:123], v[32:35]
  v_mfma_f32_16x16x32_bf16 v[32:35], a[0:3], v[120:123], v[32:35]
  v_mfma_f32_16x16x32_bf16 v[36:39], a[4:7], v[120:123], v[36:39]
  v_mfma_f32_16x16x32_bf16 v[40:43], a[8:11], v[120:123], v[40:43]
  v_mfma_f32_16x16x32_bf16 v[44:47], a[12:15], v[120:123], v[44:47]
  v_mfma_f32_16x16x32_bf16 v[48:51], a[16:19], v[120:123], v[48:51]
  v_mfma_f32_16x16x32_bf16 v[52:55], a[20:23], v[120:123], v[52:55]
  s_waitcnt lgkmcnt(14)
  v_mfma_f32_16x16x32_bf16 v[36:39], v[20:23], v[124:127], v[36:39]
  v_mfma_f32_16x16x32_bf16 v[36:39], a[0:3], v[124:127], v[36:39]
  v_mfma_f32_16x16x32_bf16 v[40:43], a[4:7], v[124:127], v[40:43]
  v_mfma_f32_16x16x32_bf16 v[44:47], a[8:11], v[124:127], v[44:47]
  v_mfma_f32_16x16x32_bf16 v[48:51], a[12:15], v[124:127], v[48:51]
  v_mfma_f32_16x16x32_bf16 v[52:55], a[16:19], v[124:127], v[52:55]
  s_waitcnt lgkmcnt(13)
  v_mfma_f32_16x16x32_bf16 v[32:35], a[32:35], v[128:131], v[32:35]
  v_mfma_f32_16x16x32_bf16 v[36:39], a[36:39], v[128:131], v[36:39]
  v_mfma_f32_16x16x32_bf16 v[40:43], a[40:43], v[128:131], v[40:43]
  v_mfma_f32_16x16x32_bf16 v[44:47], a[44:47], v[128:131], v[44:47]
  v_mfma_f32_16x16x32_bf16 v[48:51], a[48:51], v[128:131], v[48:51]
  v_mfma_f32_16x16x32_bf16 v[52:55], a[52:55], v[128:131], v[52:55]
  s_waitcnt lgkmcnt(12)
  v_mfma_f32_16x16x32_bf16 v[36:39], a[32:35], v[132:135], v[36:39]
  v_mfma_f32_16x16x32_bf16 v[40:43], a[36:39], v[132:135], v[40:43]
  v_mfma_f32_16x16x32_bf16 v[44:47], a[40:43], v[132:135], v[44:47]
  v_mfma_f32_16x16x32_bf16 v[48:51], a[44:47], v[132:135], v[48:51]
  v_mfma_f32_16x16x32_bf16 v[52:55], a[48:51], v[132:135], v[52:55]
  s_waitcnt lgkmcnt(11)
  v_mfma_f32_16x16x32_bf16 v[32:35], a[64:67], v[136:139], v[32:35]
  v_mfma_f32_16x16x32_bf16 v[36:39], a[68:71], v[136:139], v[36:39]
  v_mfma_f32_16x16x32_bf16 v[40:43], a[72:75], v[136:139], v[40:43]
  v_mfma_f32_16x16x32_bf16 v[44:47], a[76:79], v[136:139], v[44:47]
  v_mfma_f32_16x16x32_bf16 v[48:51], a[80:83], v[136:139], v[48:51]
  v_mfma_f32_16x16x32_bf16 v[52:55], a[84:87], v[136:139], v[52:55]
  s_waitcnt lgkmcnt(10)
  v_mfma_f32_16x16x32_bf16 v[36:39], a[64:67], v[140:143], v[36:39]
  v_mfma_f32_16x16x32_bf16 v[40:43], a[68:71], v[140:143], v[40:43]
  v_mfma_f32_16x16x32_bf16 v[44:47], a[72:75], v[140:143], v[44:47]
  v_mfma_f32_16x16x32_bf16 v[48:51], a[76:79], v[140:143], v[48:51]
  v_mfma_f32_16x16x32_bf16 v[52:55], a[80:83], v[140:143], v[52:55]
  s_waitcnt lgkmcnt(9)
  v_mfma_f32_16x16x32_bf16 v[32:35], a[96:99], v[144:147], v[32:35]
  v_mfma_f32_16x16x32_bf16 v[36:39], a[100:103], v[144:147], v[36:39]
  v_mfma_f32_16x16x32_bf16 v[40:43], a[104:107], v[144:147], v[40:43]
  v_mfma_f32_16x16x32_bf16 v[44:47], a[108:111], v[144:147], v[44:47]
  v_mfma_f32_16x16x32_bf16 v[48:51], a[112:115], v[144:147], v[48:51]
  v_mfma_f32_16x16x32_bf16 v[52:55], a[116:119], v[144:147], v[52:55]
  s_waitcnt lgkmcnt(8)
  v_mfma_f32_16x16x32_bf16 v[36:39], a[96:99], v[148:151], v[36:39]
  v_mfma_f32_16x16x32_bf16 v[40:43], a[100:103], v[148:151], v[40:43]
  v_mfma_f32_16x16x32_bf16 v[44:47], a[104:107], v[148:151], v[44:47]
  v_mfma_f32_16x16x32_bf16 v[48:51], a[108:111], v[148:151], v[48:51]
  v_mfma_f32_16x16x32_bf16 v[52:55], a[112:115], v[148:151], v[52:55]
  s_waitcnt lgkmcnt(7)
  v_mfma_f32_16x16x32_bf16 v[32:35], a[128:131], v[152:155], v[32:35]
  v_mfma_f32_16x16x32_bf16 v[36:39], a[132:135], v[152:155], v[36:39]
  v_mfma_f32_16x16x32_bf16 v[40:43], a[136:139], v[152:155], v[40:43]
  s_waitcnt vmcnt(0)
  v_cmp_ne_u32 vcc, 0, v19
  s_nop 1
  s_or_b64 vcc, vcc, s[50:51]
  s_cmp_eq_u64 vcc, -1
  s_cbranch_scc0 L1_slow
L1_back:
  s_barrier
  v_mfma_f32_16x16x32_bf16 v[44:47], a[140:143], v[152:155], v[44:47]
  s_mov_b32 m0, s40
  s_nop 0
  buffer_load_dwordx4 v4, s[20:23], s32 offen offset:0 sc1 lds
  v_mfma_f32_16x16x32_bf16 v[48:51], a[144:147], v[152:155], v[48:51]
  v_max3_u32 v3, v192, v193, v194
  v_max_u32 v3, v3, v195
  v_cmp_eq_u32 vcc, -1, v3
  s_nop 1
  s_cbranch_vccnz L1_ks2
L1_kb2:
  ds_write_b128 v10, v[192:195] offset:9344
  v_mfma_f32_16x16x32_bf16 v[52:55], a[148:151], v[152:155], v[52:55]
  buffer_load_dwordx4 v4, s[20:23], s32 offen offset:1024 sc1 lds
  s_waitcnt lgkmcnt(7)
  v_mfma_f32_16x16x32_bf16 v[36:39], a[128:131], v[156:159], v[36:39]
  ds_read_b128 v[56:59], v11 offset:1536
  v_mfma_f32_16x16x32_bf16 v[40:43], a[132:135], v[156:159], v[40:43]
  ds_read_b128 v[60:63], v11 offset:1024
  buffer_load_dwordx4 v4, s[20:23], s32 offen offset:2048 sc1 lds
  v_mfma_f32_16x16x32_bf16 v[44:47], a[136:139], v[156:159], v[44:47]
  ds_read_b128 v[64:67], v11 offset:1600
  v_mfma_f32_16x16x32_bf16 v[48:51], a[140:143], v[156:159], v[48:51]
  ds_read_b128 v[68:71], v11 offset:1088
  buffer_load_dwordx4 v4, s[20:23], s32 offen offset:3072 sc1 lds
  v_mfma_f32_16x16x32_bf16 v[52:55], a[144:147], v[156:159], v[52:55]
  ds_read_b128 v[72:75], v11 offset:1664
  s_waitcnt lgkmcnt(11)
  v_mfma_f32_16x16x32_bf16 v[32:35], a[160:163], v[160:163], v[32:35]
  ds_read_b128 v[76:79], v11 offset:1152
  buffer_load_dwordx2 v[200:201], v16, s[20:23], s33 offen sc1
  s_add_u32 s33, s33, 328704
  v_mfma_f32_16x16x32_bf16 v[36:39], a[164:167], v[160:163], v[36:39]
  ds_read_b128 v[80:83], v11 offset:1728
  v_mfma_f32_16x16x32_bf16 v[40:43], a[168:171], v[160:163], v[40:43]
  ds_read_b128 v[84:87], v11 offset:1216
  buffer_load_dwordx2 v[202:203], v16, s[20:23], s33 offen sc1
  s_add_u32 s33, s33, 328704
  v_mfma_f32_16x16x32_bf16 v[44:47], a[172:175], v[160:163], v[44:47]
  ds_read_b128 v[88:91], v11 offset:1792
  v_mfma_f32_16x16x32_bf16 v[48:51], a[176:179], v[160:163], v[48:51]
  ds_read_b128 v[92:95], v11 offset:1280
  buffer_load_dwordx2 v[204:205], v16, s[20:23], s33 offen sc1
  s_add_u32 s33, s33, 328704
  v_mfma_f32_16x16x32_bf16 v[52:55], a[180:183], v[160:163], v[52:55]
  ds_read_b128 v[96:99], v11 offset:1856
  s_waitcnt lgkmcnt(15)
  v_mfma_f32_16x16x32_bf16 v[36:39], a[160:163], v[164:167], v[36:39]
  ds_read_b128 v[100:103], v11 offset:1344
  buffer_load_dwordx2 v[206:207], v16, s[20:23], s33 offen sc1
  s_add_u32 s33, s33, 328704
  v_mfma_f32_16x16x32_bf16 v[40:43], a[164:167], v[164:167], v[40:43]
  ds_read_b128 v[104:107], v11 offset:1920
  v_mfma_f32_16x16x32_bf16 v[44:47], a[168:171], v[164:167], v[44:47]
  ds_read_b128 v[108:111], v11 offset:1408
  buffer_load_dwordx2 v[208:209], v16, s[20:23], s33 offen sc1
  s_add_u32 s33, s33, 328704
  v_mfma_f32_16x16x32_bf16 v[48:51], a[172:175], v[164:167], v[48:51]
  ds_read_b128 v[112:115], v11 offset:1984
  v_mfma_f32_16x16x32_bf16 v[52:55], a[176:179], v[164:167], v[52:55]
  ds_read_b128 v[116:119], v11 offset:1472
  buffer_load_dwordx2 v[210:211], v16, s[20:23], s33 offen sc1
  s_add_u32 s33, s33, 328704
  v_mfma_f32_16x16x32_bf16 v[32:35], a[192:195], v[168:171], v[32:35]
  v_mfma_f32_16x16x32_bf16 v[36:39], a[196:199], v[168:171], v[36:39]
  buffer_load_dwordx2 v[212:213], v16, s[20:23], s33 offen sc1
  s_add_u32 s33, s33, 328704
  v_mfma_f32_16x16x32_bf16 v[40:43], a[200:203], v[168:171], v[40:43]
  v_mfma_f32_16x16x32_bf16 v[44:47], a[204:207], v[168:171], v[44:47]
  buffer_load_dwordx2 v[214:215], v16, s[20:23], s33 offen sc1
  v_mfma_f32_16x16x32_bf16 v[48:51], a[208:211], v[168:171], v[48:51]
  v_mfma_f32_16x16x32_bf16 v[52:55], a[212:215], v[168:171], v[52:55]
  s_waitcnt lgkmcnt(15)
  v_mfma_f32_16x16x32_bf16 v[36:39], a[192:195], v[172:175], v[36:39]
  v_mfma_f32_16x16x32_bf16 v[40:43], a[196:199], v[172:175], v[40:43]
  v_mfma_f32_16x16x32_bf16 v[44:47], a[200:203], v[172:175], v[44:47]
  v_mfma_f32_16x16x32_bf16 v[48:51], a[204:207], v[172:175], v[48:51]
  v_mfma_f32_16x16x32_bf16 v[52:55], a[208:211], v[172:175], v[52:55]
  v_mfma_f32_16x16x32_bf16 v[32:35], a[224:227], v[176:179], v[32:35]
  v_mfma_f32_16x16x32_bf16 v[36:39], a[228:231], v[176:179], v[36:39]
  v_mfma_f32_16x16x32_bf16 v[40:43], a[232:235], v[176:179], v[40:43]
  v_mfma_f32_16x16x32_bf16 v[44:47], a[236:239], v[176:179], v[44:47]
  v_mfma_f32_16x16x32_bf16 v[48:51], a[240:243], v[176:179], v[48:51]
  v_mfma_f32_16x16x32_bf16 v[52:55], a[244:247], v[176:179], v[52:55]
  v_mfma_f32_16x16x32_bf16 v[36:39], a[224:227], v[180:183], v[36:39]
  v_mfma_f32_16x16x32_bf16 v[40:43], a[228:231], v[180:183], v[40:43]
  v_mfma_f32_16x16x32_bf16 v[44:47], a[232:235], v[180:183], v[44:47]
  v_mfma_f32_16x16x32_bf16 v[48:51], a[236:239], v[180:183], v[48:51]
  v_mfma_f32_16x16x32_bf16 v[52:55], a[240:243], v[180:183], v[52:55]
  v_mfma_f32_16x16x32_bf16 v[40:43], v[20:23], v[56:59], v[40:43]
  v_mfma_f32_16x16x32_bf16 v[40:43], a[0:3], v[56:59], v[40:43]
  v_mfma_f32_16x16x32_bf16 v[44:47], a[4:7], v[56:59], v[44:47]
  v_mfma_f32_16x16x32_bf16 v[48:51], a[8:11], v[56:59], v[48:51]
  v_mfma_f32_16x16x32_bf16 v[52:55], a[12:15], v[56:59], v[52:55]
  s_waitcnt lgkmcnt(14)
  v_mfma_f32_16x16x32_bf16 v[44:47], v[20:23], v[60:63], v[44:47]
  v_mfma_f32_16x16x32_bf16 v[44:47], a[0:3], v[60:63], v[44:47]
  v_mfma_f32_16x16x32_bf16 v[48:51], a[4:7], v[60:63], v[48:51]
  v_mfma_f32_16x16x32_bf16 v[52:55], a[8:11], v[60:63], v[52:55]
  s_waitcnt lgkmcnt(13)
  v_mfma_f32_16x16x32_bf16 v[40:43], a[32:35], v[64:67], v[40:43]
  v_mfma_f32_16x16x32_bf16 v[44:47], a[36:39], v[64:67], v[44:47]
  v_mfma_f32_16x16x32_bf16 v[48:51], a[40:43], v[64:67], v[48:51]
  v_mfma_f32_16x16x32_bf16 v[52:55], a[44:47], v[64:67], v[52:55]
  s_waitcnt lgkmcnt(12)
  v_mfma_f32_16x16x32_bf16 v[44:47], a[32:35], v[68:71], v[44:47]
  v_mfma_f32_16x16x32_bf16 v[48:51], a[36:39], v[68:71], v[48:51]
  v_mfma_f32_16x16x32_bf16 v[52:55], a[40:43], v[68:71], v[52:55]
  s_waitcnt lgkmcnt(11)
  v_mfma_f32_16x16x32_bf16 v[40:43], a[64:67], v[72:75], v[40:43]
  v_mfma_f32_16x16x32_bf16 v[44:47], a[68:71], v[72:75], v[44:47]
  v_mfma_f32_16x16x32_bf16 v[48:51], a[72:75], v[72:75], v[48:51]
  v_mfma_f32_16x16x32_bf16 v[52:55], a[76:79], v[72:75], v[52:55]
  s_waitcnt lgkmcnt(10)
  v_mfma_f32_16x16x32_bf16 v[44:47], a[64:67], v[76:79], v[44:47]
  v_mfma_f32_16x16x32_bf16 v[48:51], a[68:71], v[76:79], v[48:51]
  v_mfma_f32_16x16x32_bf16 v[52:55], a[72:75], v[76:79], v[52:55]
  s_waitcnt lgkmcnt(9)
  v_mfma_f32_16x16x32_bf16 v[40:43], a[96:99], v[80:83], v[40:43]
  v_mfma_f32_16x16x32_bf16 v[44:47], a[100:103], v[80:83], v[44:47]
  v_mfma_f32_16x16x32_bf16 v[48:51], a[104:107], v[80:83], v[48:51]
  v_mfma_f32_16x16x32_bf16 v[52:55], a[108:111], v[80:83], v[52:55]
  s_waitcnt lgkmcnt(8)
  v_mfma_f32_16x16x32_bf16 v[44:47], a[96:99], v[84:87], v[44:47]
  v_mfma_f32_16x16x32_bf16 v[48:51], a[100:103], v[84:87], v[48:51]
  v_max3_u32 v3, v196, v197, v198
  v_max_u32 v3, v3, v199
  v_cmp_eq_u32 vcc, -1, v3
  s_nop 1
  s_cbranch_vccnz L1_ks3
L1_kb3:
  ds_write_b128 v10, v[196:199] offset:8320
  v_mfma_f32_16x16x32_bf16 v[52:55], a[104:107], v[84:87], v[52:55]
  s_waitcnt lgkmcnt(8)
  v_mfma_f32_16x16x32_bf16 v[40:43], a[128:131], v[88:91], v[40:43]
  ds_read_b128 v[120:123], v11 offset:512
  v_mfma_f32_16x16x32_bf16 v[44:47], a[132:135], v[88:91], v[44:47]
  ds_read_b128 v[124:127], v11 offset:0
  v_mfma_f32_16x16x32_bf16 v[48:51], a[136:139], v[88:91], v[48:51]
  ds_read_b128 v[128:131], v11 offset:576
  v_mfma_f32_16x16x32_bf16 v[52:55], a[140:143], v[88:91], v[52:55]
  ds_read_b128 v[132:135], v11 offset:64
  s_waitcnt lgkmcnt(11)
  v_mfma_f32_16x16x32_bf16 v[44:47], a[128:131], v[92:95], v[44:47]
  ds_read_b128 v[136:139], v11 offset:640
  v_mfma_f32_16x16x32_bf16 v[48:51], a[132:135], v[92:95], v[48:51]
  ds_read_b128 v[140:143], v11 offset:128
  v_mfma_f32_16x16x32_bf16 v[52:55], a[136:139], v[92:95], v[52:55]
  ds_read_b128 v[144:147], v11 offset:704
  s_waitcnt lgkmcnt(13)
  v_mfma_f32_16x16x32_bf16 v[40:43], a[160:163], v[96:99], v[40:43]
  ds_read_b128 v[148:151], v11 offset:192
  v_mfma_f32_16x16x32_bf16 v[44:47], a[164:167], v[96:99], v[44:47]
  ds_read_b128 v[152:155], v11 offset:768
  v_mfma_f32_16x16x32_bf16 v[48:51], a[168:171], v[96:99], v[48:51]
  ds_read_b128 v[156:159], v11 offset:256
  v_mfma_f32_16x16x32_bf16 v[52:55], a[172:175], v[96:99], v[52:55]
  ds_read_b128 v[160:163], v11 offset:832
  s_waitcnt lgkmcnt(15)
  v_mfma_f32_16x16x32_bf16 v[44:47], a[160:163], v[100:103], v[44:47]
  ds_read_b128 v[164:167], v11 offset:320
  v_mfma_f32_16x16x32_bf16 v[48:51], a[164:167], v[100:103], v[48:51]
  ds_read_b128 v[168:171], v11 offset:896
  v_mfma_f32_16x16x32_bf16 v[52:55], a[168:171], v[100:103], v[52:55]
  ds_read_b128 v[172:175], v11 offset:384
  s_waitcnt vmcnt(8)
  s_barrier
  ds_read_b128 v[216:219], v1 offset:0
  ds_read_b128 v[220:223], v1 offset:16
  ds_read_b128 v[224:227], v1 offset:2048
  ds_read_b128 v[228:231], v1 offset:2064
  v_mfma_f32_16x16x32_bf16 v[40:43], a[192:195], v[104:107], v[40:43]
  ds_read_b128 v[176:179], v11 offset:960
  v_mfma_f32_16x16x32_bf16 v[44:47], a[196:199], v[104:107], v[44:47]
  ds_read_b128 v[180:183], v11 offset:448
  v_mfma_f32_16x16x32_bf16 v[48:51], a[200:203], v[104:107], v[48:51]
  v_mfma_f32_16x16x32_bf16 v[52:55], a[204:207], v[104:107], v[52:55]
  s_waitcnt lgkmcnt(15)
  v_mfma_f32_16x16x32_bf16 v[44:47], a[192:195], v[108:111], v[44:47]
  s_waitcnt vmcnt(7)
  v_lshlrev_b32 v232, 16, v200
  v_and_b32 v233, s35, v200
  v_lshlrev_b32 v234, 16, v201
  v_mfma_f32_16x16x32_bf16 v[48:51], a[196:199], v[108:111], v[48:51]
  v_and_b32 v235, s35, v201
  s_waitcnt lgkmcnt(5)
  v_fma_f32 v236, v232, v217, v216
  v_fma_f32 v237, v233, v219, v218
  v_mfma_f32_16x16x32_bf16 v[52:55], a[200:203], v[108:111], v[52:55]
  s_waitcnt lgkmcnt(4)
  v_fma_f32 v238, v234, v221, v220
  v_fma_f32 v239, v235, v223, v222
  s_waitcnt vmcnt(6)
  v_lshlrev_b32 v240, 16, v202
  v_mfma_f32_16x16x32_bf16 v[40:43], a[224:227], v[112:115], v[40:43]
  v_and_b32 v241, s35, v202
  v_lshlrev_b32 v242, 16, v203
  v_and_b32 v243, s35, v203
  v_mfma_f32_16x16x32_bf16 v[44:47], a[228:231], v[112:115], v[44:47]
  s_waitcnt lgkmcnt(3)
  v_fma_f32 v244, v240, v225, v224
  v_fma_f32 v245, v241, v227, v226
  s_waitcnt lgkmcnt(2)
  v_fma_f32 v246, v242, v229, v228
  v_mfma_f32_16x16x32_bf16 v[48:51], a[232:235], v[112:115], v[48:51]
  v_fma_f32 v247, v243, v231, v230
  ds_read_b128 v[216:219], v1 offset:4096
  ds_read_b128 v[220:223], v1 offset:4112
  v_mfma_f32_16x16x32_bf16 v[52:55], a[236:239], v[112:115], v[52:55]
  ds_read_b128 v[224:227], v1 offset:6144
  ds_read_b128 v[228:231], v1 offset:6160
  v_fmac_f32 v232, v236, v24
  v_mfma_f32_16x16x32_bf16 v[44:47], a[224:227], v[116:119], v[44:47]
  v_fmac_f32 v233, v237, v25
  v_fmac_f32 v234, v238, v26
  v_fmac_f32 v235, v239, v27
  v_mfma_f32_16x16x32_bf16 v[48:51], a[228:231], v[116:119], v[48:51]
  v_fmac_f32 v240, v244, v28
  v_fmac_f32 v241, v245, v29
  v_fmac_f32 v242, v246, v30
  v_mfma_f32_16x16x32_bf16 v[52:55], a[232:235], v[116:119], v[52:55]
  v_fmac_f32 v243, v247, v31
  v_cvt_pk_bf16_f32 v248, v232, v233
  v_cvt_pk_bf16_f32 v249, v234, v235
  v_mfma_f32_16x16x32_bf16 v[48:51], v[20:23], v[120:123], v[48:51]
  v_cvt_pk_bf16_f32 v250, v240, v241
  v_cvt_pk_bf16_f32 v251, v242, v243
  s_nop 0
  v_permlane16_swap_b32 v248, v250
  v_mfma_f32_16x16x32_bf16 v[48:51], a[0:3], v[120:123], v[48:51]
  v_permlane16_swap_b32 v249, v251
  buffer_store_dwordx4 v[248:251], v17, s[20:23], s34 offen sc1
  s_add_u32 s34, s34, 655360
  v_mfma_f32_16x16x32_bf16 v[52:55], a[4:7], v[120:123], v[52:55]
  s_waitcnt vmcnt(6)
  v_lshlrev_b32 v232, 16, v204
  v_and_b32 v233, s35, v204
  v_lshlrev_b32 v234, 16, v205
  v_mfma_f32_16x16x32_bf16 v[52:55], v[20:23], v[124:127], v[52:55]
  v_and_b32 v235, s35, v205
  s_waitcnt lgkmcnt(3)
  v_fma_f32 v236, v232, v217, v216
  v_fma_f32 v237, v233, v219, v218
  v_mfma_f32_16x16x32_bf16 v[52:55], a[0:3], v[124:127], v[52:55]
  s_waitcnt lgkmcnt(2)
  v_fma_f32 v238, v234, v221, v220
  v_fma_f32 v239, v235, v223, v222
  s_waitcnt vmcnt(5)
  v_lshlrev_b32 v240, 16, v206
  v_mfma_f32_16x16x32_bf16 v[48:51], a[32:35], v[128:131], v[48:51]
  v_and_b32 v241, s35, v206
  v_lshlrev_b32 v242, 16, v207
  v_and_b32 v243, s35, v207
  v_mfma_f32_16x16x32_bf16 v[52:55], a[36:39], v[128:131], v[52:55]
  s_waitcnt lgkmcnt(1)
  v_fma_f32 v244, v240, v225, v224
  v_fma_f32 v245, v241, v227, v226
  s_waitcnt lgkmcnt(0)
  v_fma_f32 v246, v242, v229, v228
  v_mfma_f32_16x16x32_bf16 v[52:55], a[32:35], v[132:135], v[52:55]
  v_fma_f32 v247, v243, v231, v230
  ds_read_b128 v[216:219], v1 offset:8192
  ds_read_b128 v[220:223], v1 offset:8208
  v_mfma_f32_16x16x32_bf16 v[48:51], a[64:67], v[136:139], v[48:51]
  ds_read_b128 v[224:227], v1 offset:10240
  ds_read_b128 v[228:231], v1 offset:10256
  v_fmac_f32 v232, v236, v32
  v_mfma_f32_16x16x32_bf16 v[52:55], a[68:71], v[136:139], v[52:55]
  v_fmac_f32 v233, v237, v33
  v_fmac_f32 v234, v238, v34
  v_fmac_f32 v235, v239, v35
  v_mfma_f32_16x16x32_bf16 v[52:55], a[64:67], v[140:143], v[52:55]
  v_fmac_f32 v240, v244, v36
  v_fmac_f32 v241, v245, v37
  v_fmac_f32 v242, v246, v38
  v_mfma_f32_16x16x32_bf16 v[48:51], a[96:99], v[144:147], v[48:51]
  v_fmac_f32 v243, v247, v39
  v_cvt_pk_bf16_f32 v252, v232, v233
  v_cvt_pk_bf16_f32 v253, v234, v235
  v_mfma_f32_16x16x32_bf16 v[52:55], a[100:103], v[144:147], v[52:55]
  v_cvt_pk_bf16_f32 v254, v240, v241
  v_cvt_pk_bf16_f32 v255, v242, v243
  s_nop 0
  v_permlane16_swap_b32 v252, v254
  v_mfma_f32_16x16x32_bf16 v[52:55], a[96:99], v[148:151], v[52:55]
  v_permlane16_swap_b32 v253, v255
  buffer_store_dwordx4 v[252:255], v17, s[20:23], s34 offen sc1
  s_add_u32 s34, s34, 655360
  v_mfma_f32_16x16x32_bf16 v[48:51], a[128:131], v[152:155], v[48:51]
  s_waitcnt vmcnt(5)
  v_lshlrev_b32 v232, 16, v208
  v_and_b32 v233, s35, v208
  v_lshlrev_b32 v234, 16, v209
  v_mfma_f32_16x16x32_bf16 v[52:55], a[132:135], v[152:155], v[52:55]
  v_and_b32 v235, s35, v209
  s_waitcnt lgkmcnt(3)
  v_fma_f32 v236, v232, v217, v216
  v_fma_f32 v237, v233, v219, v218
  v_mfma_f32_16x16x32_bf16 v[52:55], a[128:131], v[156:159], v[52:55]
  s_waitcnt lgkmcnt(2)
  v_fma_f32 v238, v234, v221, v220
  v_fma_f32 v239, v235, v223, v222
  s_waitcnt vmcnt(4)
  v_lshlrev_b32 v240, 16, v210
  v_mfma_f32_16x16x32_bf16 v[48:51], a[160:163], v[160:163], v[48:51]
  v_and_b32 v241, s35, v210
  v_lshlrev_b32 v242, 16, v211
  v_and_b32 v243, s35, v211
  v_mfma_f32_16x16x32_bf16 v[52:55], a[164:167], v[160:163], v[52:55]
  s_waitcnt lgkmcnt(1)
  v_fma_f32 v244, v240, v225, v224
  v_fma_f32 v245, v241, v227, v226
  s_waitcnt lgkmcnt(0)
  v_fma_f32 v246, v242, v229, v228
  v_mfma_f32_16x16x32_bf16 v[52:55], a[160:163], v[164:167], v[52:55]
  v_fma_f32 v247, v243, v231, v230
  ds_read_b128 v[216:219], v1 offset:12288
  ds_read_b128 v[220:223], v1 offset:12304
  v_mfma_f32_16x16x32_bf16 v[48:51], a[192:195], v[168:171], v[48:51]
  ds_read_b128 v[224:227], v1 offset:14336
  ds_read_b128 v[228:231], v1 offset:14352
  v_fmac_f32 v232, v236, v40
  v_mfma_f32_16x16x32_bf16 v[52:55], a[196:199], v[168:171], v[52:55]
  v_fmac_f32 v233, v237, v41
  v_fmac_f32 v234, v238, v42
  v_fmac_f32 v235, v239, v43
  v_mfma_f32_16x16x32_bf16 v[52:55], a[192:195], v[172:175], v[52:55]
  v_fmac_f32 v240, v244, v44
  v_fmac_f32 v241, v245, v45
  v_fmac_f32 v242, v246, v46
  v_mfma_f32_16x16x32_bf16 v[48:51], a[224:227], v[176:179], v[48:51]
  v_fmac_f32 v243, v247, v47
  v_cvt_pk_bf16_f32 v248, v232, v233
  v_cvt_pk_bf16_f32 v249, v234, v235
  v_mfma_f32_16x16x32_bf16 v[52:55], a[228:231], v[176:179], v[52:55]
  v_cvt_pk_bf16_f32 v250, v240, v241
  v_cvt_pk_bf16_f32 v251, v242, v243
  s_nop 0
  v_permlane16_swap_b32 v248, v250
  v_mfma_f32_16x16x32_bf16 v[52:55], a[224:227], v[180:183], v[52:55]
  v_permlane16_swap_b32 v249, v251
  buffer_store_dwordx4 v[248:251], v17, s[20:23], s34 offen sc1
  s_add_u32 s34, s34, 655360
  s_waitcnt vmcnt(4)
  v_lshlrev_b32 v232, 16, v212
  v_and_b32 v233, s35, v212
  v_lshlrev_b32 v234, 16, v213
  v_and_b32 v235, s35, v213
  s_waitcnt lgkmcnt(3)
  v_fma_f32 v236, v232, v217, v216
  v_fma_f32 v237, v233, v219, v218
  s_waitcnt lgkmcnt(2)
  v_fma_f32 v238, v234, v221, v220
  v_fma_f32 v239, v235, v223, v222
  s_waitcnt vmcnt(3)
  v_lshlrev_b32 v240, 16, v214
  v_and_b32 v241, s35, v214
  v_lshlrev_b32 v242, 16, v215
  v_and_b32 v243, s35, v215
  s_waitcnt lgkmcnt(1)
  v_fma_f32 v244, v240, v225, v224
  v_fma_f32 v245, v241, v227, v226
  s_waitcnt lgkmcnt(0)
  v_fma_f32 v246, v242, v229, v228
  v_fma_f32 v247, v243, v231, v230
  v_fmac_f32 v232, v236, v48
  v_fmac_f32 v233, v237, v49
  v_fmac_f32 v234, v238, v50
  v_fmac_f32 v235, v239, v51
  v_fmac_f32 v240, v244, v52
  v_fmac_f32 v241, v245, v53
  v_fmac_f32 v242, v246, v54
  v_fmac_f32 v243, v247, v55
  v_cvt_pk_bf16_f32 v252, v232, v233
  v_cvt_pk_bf16_f32 v253, v234, v235
  v_cvt_pk_bf16_f32 v254, v240, v241
  v_cvt_pk_bf16_f32 v255, v242, v243
  s_nop 0
  v_permlane16_swap_b32 v252, v254
  v_permlane16_swap_b32 v253, v255
  buffer_store_dwordx4 v[252:255], v17, s[20:23], s34 offen sc1
  s_mov_b64 exec, -1
  s_branch L2_join0
L1_slow:
  s_cmp_eq_u32 s44, 0
  s_cbranch_scc1 L1_back
  s_sub_u32 s44, s44, 1
  s_sleep 8
  buffer_load_dword v19, v18, s[16:19], 0 offen sc1
  s_waitcnt vmcnt(0)
  v_cmp_ne_u32 vcc, 0, v19
  s_nop 1
  s_cmp_eq_u64 vcc, -1
  s_cbranch_scc0 L1_slow
  s_branch L1_back
L1_fs:
  s_cmp_eq_u32 s44, 0
  s_cbranch_scc1 L1_fb
  s_sub_u32 s44, s44, 1
  s_sleep 8
  buffer_load_dword v19, v18, s[20:23], s73 offen sc1
  s_waitcnt vmcnt(0)
  v_cmp_eq_u32 vcc, s45, v19
  s_nop 1
  s_cmp_eq_u64 vcc, -1
  s_cbranch_scc0 L1_fs
  s_branch L1_fb
L1_ks0:
  s_cmp_eq_u32 s44, 0
  s_cbranch_scc1 L1_kb0
  s_sub_u32 s44, s44, 1
  buffer_load_dwordx4 v[184:187], v4, s[20:23], s67 offen offset:3072 sc1
  s_waitcnt vmcnt(0)
  v_max3_u32 v3, v184, v185, v186
  v_max_u32 v3, v3, v187
  v_cmp_eq_u32 vcc, -1, v3
  s_nop 1
  s_cbranch_vccnz L1_ks0
  buffer_load_dwordx4 v[188:191], v4, s[20:23], s67 offen offset:2048 sc1
  buffer_load_dwordx4 v[192:195], v4, s[20:23], s67 offen offset:1024 sc1
  buffer_load_dwordx4 v[196:199], v4, s[20:23], s67 offen offset:0 sc1
  s_branch L1_kb0
L1_ks1:
  s_cmp_eq_u32 s44, 0
  s_cbranch_scc1 L1_kb1
  s_sub_u32 s44, s44, 1
  buffer_load_dwordx4 v[188:191], v4, s[20:23], s67 offen offset:2048 sc1
  s_waitcnt vmcnt(0)
  v_max3_u32 v3, v188, v189, v190
  v_max_u32 v3, v3, v191
  v_cmp_eq_u32 vcc, -1, v3
  s_nop 1
  s_cbranch_vccnz L1_ks1
  buffer_load_dwordx4 v[192:195], v4, s[20:23], s67 offen offset:1024 sc1
  buffer_load_dwordx4 v[196:199], v4, s[20:23], s67 offen offset:0 sc1
  s_branch L1_kb1
L1_ks2:
  s_cmp_eq_u32 s44, 0
  s_cbranch_scc1 L1_kb2
  s_sub_u32 s44, s44, 1
  buffer_load_dwordx4 v[192:195], v4, s[20:23], s67 offen offset:1024 sc1
  s_waitcnt vmcnt(0)
  v_max3_u32 v3, v192, v193, v194
  v_max_u32 v3, v3, v195
  v_cmp_eq_u32 vcc, -1, v3
  s_nop 1
  s_cbranch_vccnz L1_ks2
  buffer_load_dwordx4 v[196:199], v4, s[20:23], s67 offen offset:0 sc1
  s_branch L1_kb2
L1_ks3:
  s_cmp_eq_u32 s44, 0
  s_cbranch_scc1 L1_kb3
  s_sub_u32 s44, s44, 1
  buffer_load_dwordx4 v[196:199], v4, s[20:23], s67 offen offset:0 sc1
  s_waitcnt vmcnt(0)
  v_max3_u32 v3, v196, v197, v198
  v_max_u32 v3, v3, v199
  v_cmp_eq_u32 vcc, -1, v3
  s_nop 1
  s_cbranch_vccnz L1_ks3
  s_branch L1_kb3
L1_wd:
  s_load_dwordx2 s[8:9], s[0:1], 72
  s_mov_b32 s10, 2211840
  s_mov_b32 s11, 0x20000
  s_sub_u32 s63, s2, 224
  s_mov_b32 s78, s2
  v_add_u32 v10, 0, v2
  v_mul_u32_u24 v11, 6554, v10
  v_lshrrev_b32 v11, 16, v11
  v_mul_u32_u24 v11, 1120, v11
  v_lshl_add_u32 v4, v10, 4, v11
  v_add_u32 v10, 64, v2
  v_mul_u32_u24 v11, 6554, v10
  v_lshrrev_b32 v11, 16, v11
  v_mul_u32_u24 v11, 1120, v11
  v_lshl_add_u32 v5, v10, 4, v11
  v_add_u32 v10, 128, v2
  v_mul_u32_u24 v11, 6554, v10
  v_lshrrev_b32 v11, 16, v11
  v_mul_u32_u24 v11, 1120, v11
  v_lshl_add_u32 v6, v10, 4, v11
  v_add_u32 v10, 192, v2
  v_mul_u32_u24 v11, 6554, v10
  v_lshrrev_b32 v11, 16, v11
  v_mul_u32_u24 v11, 1120, v11
  v_lshl_add_u32 v7, v10, 4, v11
  v_add_u32 v10, 256, v2
  v_mul_u32_u24 v11, 6554, v10
  v_lshrrev_b32 v11, 16, v11
  v_mul_u32_u24 v11, 1120, v11
  v_lshl_add_u32 v8, v10, 4, v11
  s_lshr_b32 s64, s3, 1
  s_lshl1_add_u32 s64, s63, s64
  s_and_b32 s65, s3, 1
  s_mul_i32 s30, s64, 40960
  s_mul_i32 s31, s65, 640
  s_add_u32 s30, s30, s31
  s_mul_i32 s31, s3, 20480
  v_lshlrev_b32 v12, 4, v2
  s_waitcnt lgkmcnt(0)
  s_and_b32 s9, s9, 0xffff
  s_and_b32 s17, s17, 0xffff
  s_and_b32 s21, s21, 0xffff
  s_cmp_ge_u32 s63, 27
  s_cbranch_scc1 L1_z
  s_add_u32 m0, s31, 0
  s_nop 0
  buffer_load_dwordx4 v4, s[8:11], s30 offen lds
  s_add_u32 m0, s31, 1024
  s_nop 0
  buffer_load_dwordx4 v5, s[8:11], s30 offen lds
  s_add_u32 m0, s31, 2048
  s_nop 0
  buffer_load_dwordx4 v6, s[8:11], s30 offen lds
  s_add_u32 m0, s31, 3072
  s_nop 0
  buffer_load_dwordx4 v7, s[8:11], s30 offen lds
  s_add_u32 m0, s31, 4096
  s_nop 0
  buffer_load_dwordx4 v8, s[8:11], s30 offen lds
  s_add_u32 s30, s30, 160
  s_add_u32 m0, s31, 5120
  s_nop 0
  buffer_load_dwordx4 v4, s[8:11], s30 offen lds
  s_add_u32 m0, s31, 6144
  s_nop 0
  buffer_load_dwordx4 v5, s[8:11], s30 offen lds
  s_add_u32 m0, s31, 7168
  s_nop 0
  buffer_load_dwordx4 v6, s[8:11], s30 offen lds
  s_add_u32 m0, s31, 8192
  s_nop 0
  buffer_load_dwordx4 v7, s[8:11], s30 offen lds
  s_add_u32 m0, s31, 9216
  s_nop 0
  buffer_load_dwordx4 v8, s[8:11], s30 offen lds
  s_add_u32 s30, s30, 160
  s_add_u32 m0, s31, 10240
  s_nop 0
  buffer_load_dwordx4 v4, s[8:11], s30 offen lds
  s_add_u32 m0, s31, 11264
  s_nop 0
  buffer_load_dwordx4 v5, s[8:11], s30 offen lds
  s_add_u32 m0, s31, 12288
  s_nop 0
  buffer_load_dwordx4 v6, s[8:11], s30 offen lds
  s_add_u32 m0, s31, 13312
  s_nop 0
  buffer_load_dwordx4 v7, s[8:11], s30 offen lds
  s_add_u32 m0, s31, 14336
  s_nop 0
  buffer_load_dwordx4 v8, s[8:11], s30 offen lds
  s_add_u32 s30, s30, 160
  s_add_u32 m0, s31, 15360
  s_nop 0
  buffer_load_dwordx4 v4, s[8:11], s30 offen lds
  s_add_u32 m0, s31, 16384
  s_nop 0
  buffer_load_dwordx4 v5, s[8:11], s30 offen lds
  s_add_u32 m0, s31, 17408
  s_nop 0
  buffer_load_dwordx4 v6, s[8:11], s30 offen lds
  s_add_u32 m0, s31, 18432
  s_nop 0
  buffer_load_dwordx4 v7, s[8:11], s30 offen lds
  s_add_u32 m0, s31, 19456
  s_nop 0
  buffer_load_dwordx4 v8, s[8:11], s30 offen lds
  v_lshrrev_b32 v10, 2, v2
  v_mul_u32_u24 v10, 160, v10
  v_and_b32 v11, 3, v2
  v_mul_u32_u24 v11, 40, v11
  v_add3_u32 v10, v10, v11, s31
  v_add_u32 v13, 4096, v12
  s_mul_i32 s32, s65, 1105920
  s_mul_i32 s33, s64, 5120
  s_add_u32 s32, s32, s33
  s_add_u32 s32, s32, 12460032
  s_waitcnt vmcnt(15)
  ds_read_b64_tr_b16 v[24:25], v10 offset:0
  ds_read_b64_tr_b16 v[26:27], v10 offset:2560
  ds_read_b64_tr_b16 v[28:29], v10 offset:8
  ds_read_b64_tr_b16 v[30:31], v10 offset:2568
  ds_read_b64_tr_b16 v[32:33], v10 offset:16
  ds_read_b64_tr_b16 v[34:35], v10 offset:2576
  ds_read_b64_tr_b16 v[36:37], v10 offset:24
  ds_read_b64_tr_b16 v[38:39], v10 offset:2584
  ds_read_b64_tr_b16 v[40:41], v10 offset:32
  ds_read_b64_tr_b16 v[42:43], v10 offset:2592
  s_waitcnt lgkmcnt(8)
  buffer_store_dwordx4 v[24:27], v12, s[20:23], s32 offen offset:0 sc1
  s_waitcnt lgkmcnt(6)
  buffer_store_dwordx4 v[28:31], v12, s[20:23], s32 offen offset:1024 sc1
  s_waitcnt lgkmcnt(4)
  buffer_store_dwordx4 v[32:35], v12, s[20:23], s32 offen offset:2048 sc1
  s_waitcnt lgkmcnt(2)
  buffer_store_dwordx4 v[36:39], v12, s[20:23], s32 offen offset:3072 sc1
  s_waitcnt lgkmcnt(0)
  buffer_store_dwordx4 v[40:43], v13, s[20:23], s32 offen sc1
  s_add_u32 s32, s32, 276480
  s_waitcnt vmcnt(15)
  ds_read_b64_tr_b16 v[44:45], v10 offset:5120
  ds_read_b64_tr_b16 v[46:47], v10 offset:7680
  ds_read_b64_tr_b16 v[48:49], v10 offset:5128
  ds_read_b64_tr_b16 v[50:51], v10 offset:7688
  ds_read_b64_tr_b16 v[52:53], v10 offset:5136
  ds_read_b64_tr_b16 v[54:55], v10 offset:7696
  ds_read_b64_tr_b16 v[56:57], v10 offset:5144
  ds_read_b64_tr_b16 v[58:59], v10 offset:7704
  ds_read_b64_tr_b16 v[60:61], v10 offset:5152
  ds_read_b64_tr_b16 v[62:63], v10 offset:7712
  s_waitcnt lgkmcnt(8)
  buffer_store_dwordx4 v[44:47], v12, s[20:23], s32 offen offset:0 sc1
  s_waitcnt lgkmcnt(6)
  buffer_store_dwordx4 v[48:51], v12, s[20:23], s32 offen offset:1024 sc1
  s_waitcnt lgkmcnt(4)
  buffer_store_dwordx4 v[52:55], v12, s[20:23], s32 offen offset:2048 sc1
  s_waitcnt lgkmcnt(2)
  buffer_store_dwordx4 v[56:59], v12, s[20:23], s32 offen offset:3072 sc1
  s_waitcnt lgkmcnt(0)
  buffer_store_dwordx4 v[60:63], v13, s[20:23], s32 offen sc1
  s_add_u32 s32, s32, 276480
  s_waitcnt vmcnt(15)
  ds_read_b64_tr_b16 v[64:65], v10 offset:10240
  ds_read_b64_tr_b16 v[66:67], v10 offset:12800
  ds_read_b64_tr_b16 v[68:69], v10 offset:10248
  ds_read_b64_tr_b16 v[70:71], v10 offset:12808
  ds_read_b64_tr_b16 v[72:73], v10 offset:10256
  ds_read_b64_tr_b16 v[74:75], v10 offset:12816
  ds_read_b64_tr_b16 v[76:77], v10 offset:10264
  ds_read_b64_tr_b16 v[78:79], v10 offset:12824
  ds_read_b64_tr_b16 v[80:81], v10 offset:10272
  ds_read_b64_tr_b16 v[82:83], v10 offset:12832
  s_waitcnt lgkmcnt(8)
  buffer_store_dwordx4 v[64:67], v12, s[20:23], s32 offen offset:0 sc1
  s_waitcnt lgkmcnt(6)
  buffer_store_dwordx4 v[68:71], v12, s[20:23], s32 offen offset:1024 sc1
  s_waitcnt lgkmcnt(4)
  buffer_store_dwordx4 v[72:75], v12, s[20:23], s32 offen offset:2048 sc1
  s_waitcnt lgkmcnt(2)
  buffer_store_dwordx4 v[76:79], v12, s[20:23], s32 offen offset:3072 sc1
  s_waitcnt lgkmcnt(0)
  buffer_store_dwordx4 v[80:83], v13, s[20:23], s32 offen sc1
  s_add_u32 s32, s32, 276480
  s_waitcnt vmcnt(15)
  ds_read_b64_tr_b16 v[84:85], v10 offset:15360
  ds_read_b64_tr_b16 v[86:87], v10 offset:17920
  ds_read_b64_tr_b16 v[88:89], v10 offset:15368
  ds_read_b64_tr_b16 v[90:91], v10 offset:17928
  ds_read_b64_tr_b16 v[92:93], v10 offset:15376
  ds_read_b64_tr_b16 v[94:95], v10 offset:17936
  ds_read_b64_tr_b16 v[96:97], v10 offset:15384
  ds_read_b64_tr_b16 v[98:99], v10 offset:17944
  ds_read_b64_tr_b16 v[100:101], v10 offset:15392
  ds_read_b64_tr_b16 v[102:103], v10 offset:17952
  s_waitcnt lgkmcnt(8)
  buffer_store_dwordx4 v[84:87], v12, s[20:23], s32 offen offset:0 sc1
  s_waitcnt lgkmcnt(6)
  buffer_store_dwordx4 v[88:91], v12, s[20:23], s32 offen offset:1024 sc1
  s_waitcnt lgkmcnt(4)
  buffer_store_dwordx4 v[92:95], v12, s[20:23], s32 offen offset:2048 sc1
  s_waitcnt lgkmcnt(2)
  buffer_store_dwordx4 v[96:99], v12, s[20:23], s32 offen offset:3072 sc1
  s_waitcnt lgkmcnt(0)
  buffer_store_dwordx4 v[100:103], v13, s[20:23], s32 offen sc1
  s_mov_b64 exec, -1
  s_branch L2_join2
L1_z:
  s_mov_b64 exec, -1
  s_branch L2_join2
L1_end:
  s_endpgm
L2_join2:
  s_cmp_lg_u32 s3, 0
  s_cbranch_scc1 L2_j2b
  v_and_b32 v18, 63, v0
  v_lshlrev_b32 v18, 2, v18
  s_mov_b32 s28, 200000
L2_join2s:
  buffer_load_dword v19, v18, s[16:19], 0 offen sc1
  s_sub_u32 s28, s28, 1
  s_waitcnt vmcnt(0)
  s_cbranch_scc1 L2_j2b
  v_cmp_ne_u32 vcc, 0, v19
  s_nop 1
  s_cmp_eq_u64 vcc, -1
  s_cbranch_scc1 L2_j2b
  s_sleep 8
  s_branch L2_join2s
L2_j2b:
  s_barrier
  s_branch L2_join0
L2_join1:
  v_and_b32 v18, 63, v0
  v_lshlrev_b32 v18, 2, v18
  s_mov_b32 s28, 200000
L2_join1s:
  buffer_load_dword v19, v18, s[16:19], 0 offen sc1
  s_sub_u32 s28, s28, 1
  s_waitcnt vmcnt(0)
  s_cbranch_scc1 L2_join0
  v_cmp_ne_u32 vcc, 0, v19
  s_nop 1
  s_cmp_eq_u64 vcc, -1
  s_cbranch_scc1 L2_join0
  s_sleep 8
  s_branch L2_join1s
L2_join0:
  s_mov_b32 s22, 25100288
  s_mov_b32 s23, 0x20000
  v_lshrrev_b32 v1, 6, v0
  v_and_b32 v2, 63, v0
  v_readfirstlane_b32 s3, v1
  s_and_b32 s4, s2, 1
  s_lshl_b32 s4, s4, 3
  s_bfe_u32 s5, s2, 0x30003
  s_add_u32 s4, s4, s5
  s_bfe_u32 s5, s2, 0x20001
  s_lshl_b32 s5, s5, 2
  s_lshr_b32 s6, s2, 6
  s_add_u32 s5, s5, s6
  s_lshr_b32 s6, s3, 1
  s_and_b32 s7, s3, 1
  v_lshlrev_b32 v3, 4, v2
  v_add_u32 v4, 4096, v3
  s_mul_i32 s8, s3, 7168
  s_mul_i32 s9, s5, 286720
  s_add_u32 s9, s9, s8
  s_add_u32 s9, s9, 7872512
  s_add_u32 s8, s8, 49152
  s_lshl_b32 s10, s3, 12
  s_mul_i32 s11, s4, 163840
  s_add_u32 s11, s11, s10
  s_add_u32 s11, s11, 5251072
  s_and_b32 s73, s2, 3
  s_mul_i32 s73, s73, 65792
  s_add_u32 s73, s73, 4194304
  s_lshl2_add_u32 s72, s5, 160
  v_mov_b32 v26, s72
  v_cmp_gt_u32 vcc, 4, v2
  s_nop 1
  v_cndmask_b32 v26, -4, v26, vcc
  v_add_u32 v26, v26, v2
  v_cmp_ne_u32 vcc, s78, v26
  v_mul_u32_u24 v26, 256, v26
  s_cmp_eq_u32 s3, 0
  s_cselect_b32 s75, 0xf, 0
  s_cselect_b32 s74, -1, 1
  s_and_b64 s[74:75], vcc, s[74:75]
  v_mov_b32 v27, 0x7ff00000
  v_cndmask_b32 v26, v27, v26, s[74:75]
  buffer_load_dword v28, v26, s[20:23], s73 offen sc1
  s_mul_i32 s72, s78, 256
  s_add_u32 s72, s72, 4194304
  v_mul_u32_u24 v24, 65792, v2
  s_cmp_eq_u32 s3, 0
  s_cselect_b32 s15, 0, 0x7ff00000
  v_or_b32 v24, s15, v24
  s_waitcnt vmcnt(1) lgkmcnt(0)
  s_barrier
  s_mov_b64 exec, 0xf
  buffer_store_dword v27, v24, s[20:23], s72 offen sc1
  s_mov_b64 exec, -1
  s_load_dwordx2 s[48:49], s[0:1], 80
  s_mov_b32 s39, 200000
  s_waitcnt vmcnt(1)
L2_sp2:
  v_cmp_eq_u32 vcc, 0, v28
  s_nop 1
  s_and_b64 s[74:75], vcc, s[74:75]
  s_cbranch_scc0 L2_p2
  s_mov_b64 exec, s[74:75]
  buffer_load_dword v28, v26, s[20:23], s73 offen sc1
  s_mov_b64 exec, -1
  s_and_b32 s15, s74, 1
  s_cbranch_scc0 L2_p2
  s_cmp_eq_u32 s39, 0
  s_cbranch_scc1 L2_p2
  s_sub_u32 s39, s39, 1
  s_waitcnt vmcnt(0)
  s_branch L2_sp2
L2_p2:
  s_add_u32 m0, s8, 0
  s_nop 0
  buffer_load_dwordx4 v3, s[20:23], s9 offen offset:0 lds
  buffer_load_dwordx4 v3, s[20:23], s9 offen offset:1024 lds
  buffer_load_dwordx4 v3, s[20:23], s9 offen offset:2048 lds
  buffer_load_dwordx4 v3, s[20:23], s9 offen offset:3072 lds
  s_add_u32 m0, s8, 4096
  s_nop 0
  buffer_load_dwordx4 v4, s[20:23], s9 offen offset:0 lds
  buffer_load_dwordx4 v4, s[20:23], s9 offen offset:1024 lds
  buffer_load_dwordx4 v4, s[20:23], s9 offen offset:2048 lds
  s_add_u32 s9, s9, 28672
  s_add_u32 m0, s8, 28672
  s_nop 0
  buffer_load_dwordx4 v3, s[20:23], s9 offen offset:0 lds
  buffer_load_dwordx4 v3, s[20:23], s9 offen offset:1024 lds
  buffer_load_dwordx4 v3, s[20:23], s9 offen offset:2048 lds
  buffer_load_dwordx4 v3, s[20:23], s9 offen offset:3072 lds
  s_add_u32 m0, s8, 32768
  s_nop 0
  buffer_load_dwordx4 v4, s[20:23], s9 offen offset:0 lds
  buffer_load_dwordx4 v4, s[20:23], s9 offen offset:1024 lds
  buffer_load_dwordx4 v4, s[20:23], s9 offen offset:2048 lds
  s_add_u32 s9, s9, 28672
  s_mul_i32 s15, s3, 39
  v_min_u32 v253, 38, v2
  v_add_u32 v253, s15, v253
  v_min_u32 v253, 154, v253
  v_cmp_le_u32 vcc, 128, v253
  s_nop 1
  v_cndmask_b32 v255, 0, 64, vcc
  v_add3_u32 v253, v253, v255, 32
  v_cmp_eq_u32 vcc, s78, v253
  s_nop 1
  v_cndmask_b32 v255, 0, 1, vcc
  v_sub_u32 v253, v253, v255
  v_mul_u32_u24 v253, 256, v253
  s_waitcnt lgkmcnt(0)
  s_and_b32 s52, s2, 1
  s_lshl_b32 s52, s52, 4
  s_bfe_u32 s53, s2, 0x20001
  s_lshl2_add_u32 s52, s53, s52
  s_bfe_u32 s53, s2, 0x20003
  s_add_u32 s52, s52, s53
  s_lshr_b32 s53, s2, 5
  s_mov_b32 s50, 2621440
  s_mov_b32 s51, 0x20000
  s_mov_b32 s42, 276480
  s_mov_b32 s43, 0x20000
  s_mov_b32 s46, 221184
  s_mov_b32 s47, 0x20000
  s_and_b32 s49, s49, 0xffff
  s_mul_i32 s55, s53, 276480
  s_add_u32 s55, s55, 12460032
  s_mul_i32 s56, s52, 229376
  s_add_u32 s56, s56, 14729216
  s_add_u32 s40, s20, s55
  s_addc_u32 s41, s21, 0
  s_add_u32 s44, s20, s56
  s_addc_u32 s45, s21, 0
  s_mul_i32 s54, s3, 35840
  s_add_u32 s54, s54, 15360
  s_mul_i32 s13, s7, 7168
  s_add_u32 s13, s13, 49152
  v_add_u32 v6, s13, v3
  v_add_u32 v7, 57344, v6
  v_lshrrev_b32 v12, 2, v2
  v_and_b32 v13, 7, v12
  v_lshlrev_b32 v12, 8, v12
  v_and_b32 v14, 3, v2
  v_lshl_add_u32 v12, v14, 3, v12
  s_lshl_b32 s14, s6, 2
  s_lshl_b32 s15, s7, 1
  s_or_b32 s14, s14, s15
  s_xor_b32 s15, s14, 0
  v_xor_b32 v14, s15, v13
  v_lshl_add_u32 v8, v14, 5, v12
  s_xor_b32 s15, s14, 1
  v_xor_b32 v14, s15, v13
  v_lshl_add_u32 v9, v14, 5, v12
  s_xor_b32 s15, s14, 2
  v_xor_b32 v14, s15, v13
  v_lshl_add_u32 v10, v14, 5, v12
  s_xor_b32 s15, s14, 3
  v_xor_b32 v14, s15, v13
  v_lshl_add_u32 v11, v14, 5, v12
  v_mov_b32 v152, 0x3f803f80
  v_mov_b32 v153, 0x3f803f80
  v_mov_b32 v154, 0x3f803f80
  v_mov_b32 v155, 0x3f803f80
  s_mul_i32 s12, s5, 896
  s_add_u32 s12, s12, 14671872
  v_min_u32 v5, 223, v0
  v_lshlrev_b32 v5, 2, v5
  v_lshrrev_b32 v248, 1, v2
  v_and_b32 v22, 7, v248
  v_lshlrev_b32 v248, 8, v248
  s_and_b32 s55, s52, 1
  s_lshl2_add_u32 s55, s55, s3
  v_xor_b32 v22, s55, v22
  v_lshl_add_u32 v248, v22, 5, v248
  v_and_b32 v22, 1, v2
  v_lshl_add_u32 v248, v22, 4, v248
  s_lshr_b32 s55, s52, 1
  s_mul_i32 s55, s55, 163840
  s_mul_i32 s56, s53, 20480
  s_add_u32 s55, s55, s56
  s_add_u32 s55, s55, 5251072
  s_mul_i32 s57, s3, 3072
  s_add_u32 s57, s57, 137216
  s_lshr_b32 s16, s5, 1
  s_mul_i32 s16, s16, 7
  s_and_b32 s17, s5, 1
  s_lshl_b32 s18, s4, 1
  s_add_u32 s18, s18, s6
  s_mul_i32 s18, s18, 229376
  s_add_u32 s18, s18, 14729216
  s_lshl_b32 s19, s16, 12
  s_add_u32 s18, s18, s19
  s_lshl1_add_u32 s19, s17, s7
  s_lshl_b32 s19, s19, 8
  s_add_u32 s34, s18, s19
  s_add_u32 s34, s34, 12288
  s_lshl_b32 s35, s7, 11
  s_add_u32 s18, s18, s35
  s_lshl_b32 s19, s17, 14
  s_add_u32 s30, s18, s19
  s_lshl_b32 s19, s7, 9
  s_add_u32 s32, s30, s19
  s_add_u32 s32, s32, 8192
  s_lshl_b32 s19, s7, 12
  s_add_u32 s30, s30, s19
  s_xor_b32 s31, s30, 2048
  s_xor_b32 s33, s32, 2048
  v_and_b32 v20, 31, v2
  v_lshlrev_b32 v20, 4, v20
  v_lshrrev_b32 v23, 5, v2
  v_lshl_add_u32 v20, v23, 10, v20
  v_and_b32 v23, 0x100, v20
  v_xor_b32 v22, v20, v23
  v_lshl_or_b32 v23, v23, 3, v22
  v_xor_b32 v23, s35, v23
  v_mov_b32 v244, -1
  v_mov_b32 v245, -1
  v_mov_b32 v246, -1
  v_mov_b32 v247, -1
  s_lshl1_add_u32 s36, s4, s6
  s_lshl_b32 s36, s36, 9
  s_lshl1_add_u32 s37, s5, s7
  s_lshl2_add_u32 s36, s37, s36
  s_add_u32 s36, s36, 22134784
  s_lshl_b32 s37, s52, 9
  s_add_u32 s37, s37, 22134784
  v_and_b32 v22, 31, v2
  v_lshlrev_b32 v22, 2, v22
  s_mov_b32 s24, 0x22222222
  s_mov_b32 s25, s24
  s_mov_b32 s26, 0x44444444
  s_mov_b32 s27, s26
  s_mov_b32 s28, 0x88888888
  s_mov_b32 s29, s28
  v_and_b32 v12, 15, v2
  v_lshlrev_b32 v12, 3, v12
  s_lshl_b32 s15, s14, 7
  s_add_u32 s15, s15, 136192
  v_add_u32 v13, s15, v12
  s_xor_b32 s15, s15, 256
  v_add_u32 v14, s15, v12
  v_lshrrev_b32 v15, 4, v2
  v_lshlrev_b32 v15, 4, v15
  s_mul_i32 s13, s7, 448
  s_add_u32 s13, s13, 135168
  v_add_u32 v15, s13, v15
  s_mul_i32 s38, s3, 28672
  s_xor_b32 s15, s3, 0
  s_lshl_b32 s15, s15, 10
  s_add_u32 s15, s15, s38
  v_add_u32 v16, s15, v3
  s_xor_b32 s15, s3, 1
  s_lshl_b32 s15, s15, 10
  s_add_u32 s15, s15, s38
  v_add_u32 v17, s15, v3
  s_xor_b32 s15, s3, 2
  s_lshl_b32 s15, s15, 10
  s_add_u32 s15, s15, s38
  v_add_u32 v18, s15, v3
  s_xor_b32 s15, s3, 3
  s_lshl_b32 s15, s15, 10
  s_add_u32 s15, s15, s38
  v_add_u32 v19, s15, v3
  s_mov_b32 s58, 12288
  s_mov_b32 s59, 126976
  s_mov_b32 s60, 8192
  s_mov_b32 s61, 24576
  s_mov_b32 s62, 122880
  s_mov_b32 s63, 139264
  s_mov_b32 s64, 0
  s_mov_b32 s65, 16384
  s_mov_b32 s66, 4096
  s_mov_b32 s67, 20480
  s_mov_b32 s68, 114688
  s_mov_b32 s69, 131072
  s_mov_b32 s70, 118784
  s_mov_b32 s71, 135168
  s_cmp_eq_u64 s[74:75], 0
  s_cbranch_scc1 L2_go0
  s_cmp_lg_u32 s3, 0
  s_cbranch_scc1 L2_go0
  s_mov_b64 exec, s[74:75]
  s_waitcnt vmcnt(14)
L2_sp0:
  v_cmp_eq_u32 vcc, 0, v28
  s_cmp_eq_u32 s39, 0
  s_cbranch_scc1 L2_go0
  s_cbranch_vccz L2_go0
  s_mov_b64 exec, vcc
  s_sub_u32 s39, s39, 1
  buffer_load_dword v28, v26, s[20:23], s73 offen sc1
  s_waitcnt vmcnt(0)
  v_cmp_eq_u32 vcc, 0, v28
  s_nop 1
  s_cbranch_vccz L2_go0
  s_sleep 4
  s_branch L2_sp0
L2_go0:
  s_mov_b64 exec, -1
  s_barrier
  s_add_u32 m0, s10, 0
  s_nop 0
  buffer_load_dwordx4 v3, s[20:23], s11 offen offset:0 lds
  buffer_load_dwordx4 v3, s[20:23], s11 offen offset:1024 lds
  buffer_load_dwordx4 v3, s[20:23], s11 offen offset:2048 lds
  buffer_load_dwordx4 v3, s[20:23], s11 offen offset:3072 lds
  s_add_u32 s11, s11, 16384
  s_add_u32 m0, s10, 16384
  s_nop 0
  buffer_load_dwordx4 v3, s[20:23], s11 offen offset:0 lds
  buffer_load_dwordx4 v3, s[20:23], s11 offen offset:1024 lds
  buffer_load_dwordx4 v3, s[20:23], s11 offen offset:2048 lds
  buffer_load_dwordx4 v3, s[20:23], s11 offen offset:3072 lds
  s_add_u32 s11, s11, 16384
  buffer_load_dword v255, v253, s[20:23], s73 offen sc1
  s_waitcnt vmcnt(5)
  s_barrier
  ds_read_b64_tr_b16 v[184:185], v8 offset:0
  ds_read_b64_tr_b16 v[186:187], v8 offset:4096
  ds_read_b64_tr_b16 v[188:189], v9 offset:0
  ds_read_b64_tr_b16 v[190:191], v9 offset:4096
  ds_read_b64_tr_b16 v[192:193], v10 offset:0
  ds_read_b64_tr_b16 v[194:195], v10 offset:4096
  ds_read_b64_tr_b16 v[196:197], v11 offset:0
  ds_read_b64_tr_b16 v[198:199], v11 offset:4096
  ds_read_b128 v[156:159], v6 offset:0
  ds_read_b128 v[160:163], v6 offset:1024
  ds_read_b128 v[164:167], v6 offset:2048
  ds_read_b128 v[168:171], v6 offset:3072
  ds_read_b128 v[172:175], v6 offset:4096
  ds_read_b128 v[176:179], v6 offset:5120
  ds_read_b128 v[180:183], v6 offset:6144
  s_waitcnt lgkmcnt(13)
  v_mfma_f32_16x16x32_bf16 v[136:139], v[152:155], v[184:187], 0
  ds_read_b64_tr_b16 v[228:229], v8 offset:8192
  v_mfma_f32_16x16x32_bf16 v[144:147], v[184:187], v[184:187], 0
  ds_read_b64_tr_b16 v[230:231], v8 offset:12288
  s_waitcnt lgkmcnt(13)
  v_mfma_f32_16x16x32_bf16 v[140:143], v[152:155], v[188:191], 0
  ds_read_b64_tr_b16 v[232:233], v9 offset:8192
  s_add_u32 m0, s8, 57344
  s_nop 0
  buffer_load_dwordx4 v3, s[20:23], s9 offen offset:0 lds
  v_mfma_f32_16x16x32_bf16 v[148:151], v[188:191], v[188:191], 0
  ds_read_b64_tr_b16 v[234:235], v9 offset:12288
  s_waitcnt lgkmcnt(10)
  v_mfma_f32_16x16x32_bf16 v[24:27], v[156:159], v[184:187], 0
  ds_read_b64_tr_b16 v[236:237], v10 offset:8192
  v_mfma_f32_16x16x32_bf16 v[28:31], v[156:159], v[188:191], 0
  ds_read_b64_tr_b16 v[238:239], v10 offset:12288
  v_mfma_f32_16x16x32_bf16 v[32:35], v[156:159], v[192:195], 0
  ds_read_b64_tr_b16 v[240:241], v11 offset:8192
  buffer_load_dwordx4 v3, s[20:23], s9 offen offset:1024 lds
  v_mfma_f32_16x16x32_bf16 v[36:39], v[156:159], v[196:199], 0
  ds_read_b64_tr_b16 v[242:243], v11 offset:12288
  s_waitcnt lgkmcnt(13)
  v_mfma_f32_16x16x32_bf16 v[40:43], v[160:163], v[184:187], 0
  ds_read_b128 v[200:203], v6 offset:14336
  v_mfma_f32_16x16x32_bf16 v[44:47], v[160:163], v[188:191], 0
  ds_read_b128 v[204:207], v6 offset:15360
  v_mfma_f32_16x16x32_bf16 v[48:51], v[160:163], v[192:195], 0
  ds_read_b128 v[208:211], v6 offset:16384
  v_mfma_f32_16x16x32_bf16 v[52:55], v[160:163], v[196:199], 0
  ds_read_b128 v[212:215], v6 offset:17408
  buffer_load_dwordx4 v3, s[20:23], s9 offen offset:2048 lds
  s_waitcnt lgkmcnt(15)
  v_mfma_f32_16x16x32_bf16 v[56:59], v[164:167], v[184:187], 0
  ds_read_b128 v[216:219], v6 offset:18432
  v_mfma_f32_16x16x32_bf16 v[60:63], v[164:167], v[188:191], 0
  ds_read_b128 v[220:223], v6 offset:19456
  v_mfma_f32_16x16x32_bf16 v[64:67], v[164:167], v[192:195], 0
  ds_read_b128 v[224:227], v6 offset:20480
  v_mfma_f32_16x16x32_bf16 v[68:71], v[164:167], v[196:199], 0
  v_mfma_f32_16x16x32_bf16 v[72:75], v[168:171], v[184:187], 0
  buffer_load_dwordx4 v3, s[20:23], s9 offen offset:3072 lds
  v_mfma_f32_16x16x32_bf16 v[76:79], v[168:171], v[188:191], 0
  v_mfma_f32_16x16x32_bf16 v[80:83], v[168:171], v[192:195], 0
  v_mfma_f32_16x16x32_bf16 v[84:87], v[168:171], v[196:199], 0
  s_waitcnt lgkmcnt(15)
  v_mfma_f32_16x16x32_bf16 v[88:91], v[172:175], v[184:187], 0
  s_add_u32 m0, s8, 61440
  s_nop 0
  buffer_load_dwordx4 v4, s[20:23], s9 offen offset:0 lds
  v_mfma_f32_16x16x32_bf16 v[92:95], v[172:175], v[188:191], 0
  v_mfma_f32_16x16x32_bf16 v[96:99], v[172:175], v[192:195], 0
  v_mfma_f32_16x16x32_bf16 v[100:103], v[172:175], v[196:199], 0
  v_mfma_f32_16x16x32_bf16 v[104:107], v[176:179], v[184:187], 0
  v_mfma_f32_16x16x32_bf16 v[108:111], v[176:179], v[188:191], 0
  buffer_load_dwordx4 v4, s[20:23], s9 offen offset:1024 lds
  v_mfma_f32_16x16x32_bf16 v[112:115], v[176:179], v[192:195], 0
  v_mfma_f32_16x16x32_bf16 v[116:119], v[176:179], v[196:199], 0
  v_mfma_f32_16x16x32_bf16 v[120:123], v[180:183], v[184:187], 0
  v_mfma_f32_16x16x32_bf16 v[124:127], v[180:183], v[188:191], 0
  buffer_load_dwordx4 v4, s[20:23], s9 offen offset:2048 lds
  s_add_u32 s9, s9, 28672
  v_mfma_f32_16x16x32_bf16 v[128:131], v[180:183], v[192:195], 0
  v_mfma_f32_16x16x32_bf16 v[132:135], v[180:183], v[196:199], 0
  s_waitcnt lgkmcnt(0)
  s_waitcnt vmcnt(8)
  s_waitcnt vmcnt(7)
  v_cmp_eq_u32 vcc, 0, v255
  s_nop 1
  s_cbranch_vccnz L2_bs
L2_bb:
  s_barrier
  v_mfma_f32_16x16x32_bf16 v[136:139], v[152:155], v[228:231], v[136:139]
  ds_read_b64_tr_b16 v[184:185], v8 offset:16384
  v_mfma_f32_16x16x32_bf16 v[144:147], v[228:231], v[228:231], v[144:147]
  ds_read_b64_tr_b16 v[186:187], v8 offset:20480
  s_add_u32 m0, s10, 32768
  s_nop 0
  buffer_load_dwordx4 v3, s[20:23], s11 offen offset:0 lds
  v_mfma_f32_16x16x32_bf16 v[140:143], v[152:155], v[232:235], v[140:143]
  ds_read_b64_tr_b16 v[188:189], v9 offset:16384
  v_mfma_f32_16x16x32_bf16 v[148:151], v[232:235], v[232:235], v[148:151]
  ds_read_b64_tr_b16 v[190:191], v9 offset:20480
  v_mfma_f32_16x16x32_bf16 v[24:27], v[200:203], v[228:231], v[24:27]
  ds_read_b64_tr_b16 v[192:193], v10 offset:16384
  buffer_load_dwordx4 v3, s[20:23], s11 offen offset:1024 lds
  v_mfma_f32_16x16x32_bf16 v[28:31], v[200:203], v[232:235], v[28:31]
  ds_read_b64_tr_b16 v[194:195], v10 offset:20480
  v_mfma_f32_16x16x32_bf16 v[32:35], v[200:203], v[236:239], v[32:35]
  ds_read_b64_tr_b16 v[196:197], v11 offset:16384
  v_mfma_f32_16x16x32_bf16 v[36:39], v[200:203], v[240:243], v[36:39]
  ds_read_b64_tr_b16 v[198:199], v11 offset:20480
  buffer_load_dwordx4 v3, s[20:23], s11 offen offset:2048 lds
  v_mfma_f32_16x16x32_bf16 v[40:43], v[204:207], v[228:231], v[40:43]
  ds_read_b128 v[156:159], v6 offset:28672
  v_mfma_f32_16x16x32_bf16 v[44:47], v[204:207], v[232:235], v[44:47]
  ds_read_b128 v[160:163], v6 offset:29696
  v_mfma_f32_16x16x32_bf16 v[48:51], v[204:207], v[236:239], v[48:51]
  ds_read_b128 v[164:167], v6 offset:30720
  buffer_load_dwordx4 v3, s[20:23], s11 offen offset:3072 lds
  s_add_u32 s11, s11, 16384
  v_mfma_f32_16x16x32_bf16 v[52:55], v[204:207], v[240:243], v[52:55]
  ds_read_b128 v[168:171], v6 offset:31744
  v_mfma_f32_16x16x32_bf16 v[56:59], v[208:211], v[228:231], v[56:59]
  ds_read_b128 v[172:175], v6 offset:32768
  v_mfma_f32_16x16x32_bf16 v[60:63], v[208:211], v[232:235], v[60:63]
  ds_read_b128 v[176:179], v6 offset:33792
  s_add_u32 m0, s10, 0
  s_nop 0
  buffer_load_dwordx4 v3, s[20:23], s11 offen offset:0 lds
  v_mfma_f32_16x16x32_bf16 v[64:67], v[208:211], v[236:239], v[64:67]
  ds_read_b128 v[180:183], v6 offset:34816
  v_mfma_f32_16x16x32_bf16 v[68:71], v[208:211], v[240:243], v[68:71]
  v_mfma_f32_16x16x32_bf16 v[72:75], v[212:215], v[228:231], v[72:75]
  buffer_load_dword v249, v5, s[20:23], s12 offen
  s_add_u32 s12, s12, 14336
  buffer_load_dword v250, v5, s[20:23], s12 offen
  s_add_u32 s12, s12, 14336
  v_mfma_f32_16x16x32_bf16 v[76:79], v[212:215], v[232:235], v[76:79]
  v_mfma_f32_16x16x32_bf16 v[80:83], v[212:215], v[236:239], v[80:83]
  buffer_load_dwordx4 v3, s[20:23], s11 offen offset:1024 lds
  v_mfma_f32_16x16x32_bf16 v[84:87], v[212:215], v[240:243], v[84:87]
  v_mfma_f32_16x16x32_bf16 v[88:91], v[216:219], v[228:231], v[88:91]
  v_mfma_f32_16x16x32_bf16 v[92:95], v[216:219], v[232:235], v[92:95]
  buffer_load_dwordx4 v3, s[20:23], s11 offen offset:2048 lds
  v_mfma_f32_16x16x32_bf16 v[96:99], v[216:219], v[236:239], v[96:99]
  v_mfma_f32_16x16x32_bf16 v[100:103], v[216:219], v[240:243], v[100:103]
  v_mfma_f32_16x16x32_bf16 v[104:107], v[220:223], v[228:231], v[104:107]
  buffer_load_dwordx4 v3, s[20:23], s11 offen offset:3072 lds
  s_add_u32 s11, s11, 16384
  v_mfma_f32_16x16x32_bf16 v[108:111], v[220:223], v[232:235], v[108:111]
  v_mfma_f32_16x16x32_bf16 v[112:115], v[220:223], v[236:239], v[112:115]
  v_mfma_f32_16x16x32_bf16 v[116:119], v[220:223], v[240:243], v[116:119]
  s_add_u32 m0, s8, 0
  s_nop 0
  buffer_load_dwordx4 v3, s[20:23], s9 offen offset:0 lds
  v_mfma_f32_16x16x32_bf16 v[120:123], v[224:227], v[228:231], v[120:123]
  v_mfma_f32_16x16x32_bf16 v[124:127], v[224:227], v[232:235], v[124:127]
  v_mfma_f32_16x16x32_bf16 v[128:131], v[224:227], v[236:239], v[128:131]
  buffer_load_dwordx4 v3, s[20:23], s9 offen offset:1024 lds
  v_mfma_f32_16x16x32_bf16 v[132:135], v[224:227], v[240:243], v[132:135]
  s_waitcnt lgkmcnt(13)
  v_mfma_f32_16x16x32_bf16 v[136:139], v[152:155], v[184:187], v[136:139]
  ds_read_b64_tr_b16 v[228:229], v8 offset:24576
  v_mfma_f32_16x16x32_bf16 v[144:147], v[184:187], v[184:187], v[144:147]
  ds_read_b64_tr_b16 v[230:231], v8 offset:28672
  s_waitcnt lgkmcnt(13)
  v_mfma_f32_16x16x32_bf16 v[140:143], v[152:155], v[188:191], v[140:143]
  ds_read_b64_tr_b16 v[232:233], v9 offset:24576
  buffer_load_dwordx4 v3, s[20:23], s9 offen offset:2048 lds
  v_mfma_f32_16x16x32_bf16 v[148:151], v[188:191], v[188:191], v[148:151]
  ds_read_b64_tr_b16 v[234:235], v9 offset:28672
  s_waitcnt lgkmcnt(10)
  v_mfma_f32_16x16x32_bf16 v[24:27], v[156:159], v[184:187], v[24:27]
  ds_read_b64_tr_b16 v[236:237], v10 offset:24576
  v_mfma_f32_16x16x32_bf16 v[28:31], v[156:159], v[188:191], v[28:31]
  ds_read_b64_tr_b16 v[238:239], v10 offset:28672
  v_mfma_f32_16x16x32_bf16 v[32:35], v[156:159], v[192:195], v[32:35]
  ds_read_b64_tr_b16 v[240:241], v11 offset:24576
  buffer_load_dword v251, v5, s[20:23], s12 offen
  s_add_u32 s12, s12, 14336
  buffer_load_dword v252, v5, s[20:23], s12 offen
  v_mfma_f32_16x16x32_bf16 v[36:39], v[156:159], v[196:199], v[36:39]
  ds_read_b64_tr_b16 v[242:243], v11 offset:28672
  s_waitcnt lgkmcnt(13)
  v_mfma_f32_16x16x32_bf16 v[40:43], v[160:163], v[184:187], v[40:43]
  ds_read_b128 v[200:203], v6 offset:43008
  v_mfma_f32_16x16x32_bf16 v[44:47], v[160:163], v[188:191], v[44:47]
  ds_read_b128 v[204:207], v6 offset:44032
  v_mfma_f32_16x16x32_bf16 v[48:51], v[160:163], v[192:195], v[48:51]
  ds_read_b128 v[208:211], v6 offset:45056
  v_mfma_f32_16x16x32_bf16 v[52:55], v[160:163], v[196:199], v[52:55]
  ds_read_b128 v[212:215], v6 offset:46080
  buffer_load_dwordx4 v3, s[20:23], s9 offen offset:3072 lds
  s_waitcnt lgkmcnt(15)
  v_mfma_f32_16x16x32_bf16 v[56:59], v[164:167], v[184:187], v[56:59]
  ds_read_b128 v[216:219], v6 offset:47104
  v_mfma_f32_16x16x32_bf16 v[60:63], v[164:167], v[188:191], v[60:63]
  ds_read_b128 v[220:223], v6 offset:48128
  v_mfma_f32_16x16x32_bf16 v[64:67], v[164:167], v[192:195], v[64:67]
  ds_read_b128 v[224:227], v6 offset:49152
  v_mfma_f32_16x16x32_bf16 v[68:71], v[164:167], v[196:199], v[68:71]
  v_mfma_f32_16x16x32_bf16 v[72:75], v[168:171], v[184:187], v[72:75]
  s_add_u32 m0, s8, 4096
  s_nop 0
  buffer_load_dwordx4 v4, s[20:23], s9 offen offset:0 lds
  v_mfma_f32_16x16x32_bf16 v[76:79], v[168:171], v[188:191], v[76:79]
  v_mfma_f32_16x16x32_bf16 v[80:83], v[168:171], v[192:195], v[80:83]
  v_mfma_f32_16x16x32_bf16 v[84:87], v[168:171], v[196:199], v[84:87]
  s_waitcnt lgkmcnt(15)
  v_mfma_f32_16x16x32_bf16 v[88:91], v[172:175], v[184:187], v[88:91]
  buffer_load_dwordx4 v4, s[20:23], s9 offen offset:1024 lds
  v_mfma_f32_16x16x32_bf16 v[92:95], v[172:175], v[188:191], v[92:95]
  v_mfma_f32_16x16x32_bf16 v[96:99], v[172:175], v[192:195], v[96:99]
  v_mfma_f32_16x16x32_bf16 v[100:103], v[172:175], v[196:199], v[100:103]
  v_mfma_f32_16x16x32_bf16 v[104:107], v[176:179], v[184:187], v[104:107]
  v_mfma_f32_16x16x32_bf16 v[108:111], v[176:179], v[188:191], v[108:111]
  buffer_store_dwordx4 v[244:247], v23, s[20:23], s34 offen sc1
  v_mfma_f32_16x16x32_bf16 v[112:115], v[176:179], v[192:195], v[112:115]
  v_mfma_f32_16x16x32_bf16 v[116:119], v[176:179], v[196:199], v[116:119]
  v_mfma_f32_16x16x32_bf16 v[120:123], v[180:183], v[184:187], v[120:123]
  v_mfma_f32_16x16x32_bf16 v[124:127], v[180:183], v[188:191], v[124:127]
  buffer_load_dwordx4 v4, s[20:23], s9 offen offset:2048 lds
  s_add_u32 s9, s9, 28672
  v_mfma_f32_16x16x32_bf16 v[128:131], v[180:183], v[192:195], v[128:131]
  v_mfma_f32_16x16x32_bf16 v[132:135], v[180:183], v[196:199], v[132:135]
  s_waitcnt lgkmcnt(0)
  s_waitcnt vmcnt(16)
  s_barrier
  v_mfma_f32_16x16x32_bf16 v[136:139], v[152:155], v[228:231], v[136:139]
  ds_read_b64_tr_b16 v[184:185], v8 offset:32768
  v_mfma_f32_16x16x32_bf16 v[144:147], v[228:231], v[228:231], v[144:147]
  ds_read_b64_tr_b16 v[186:187], v8 offset:36864
  v_mfma_f32_16x16x32_bf16 v[140:143], v[152:155], v[232:235], v[140:143]
  ds_read_b64_tr_b16 v[188:189], v9 offset:32768
  s_add_u32 m0, s10, 16384
  s_nop 0
  buffer_load_dwordx4 v3, s[20:23], s11 offen offset:0 lds
  v_mfma_f32_16x16x32_bf16 v[148:151], v[232:235], v[232:235], v[148:151]
  ds_read_b64_tr_b16 v[190:191], v9 offset:36864
  v_mfma_f32_16x16x32_bf16 v[24:27], v[200:203], v[228:231], v[24:27]
  ds_read_b64_tr_b16 v[192:193], v10 offset:32768
  v_mfma_f32_16x16x32_bf16 v[28:31], v[200:203], v[232:235], v[28:31]
  ds_read_b64_tr_b16 v[194:195], v10 offset:36864
  v_mfma_f32_16x16x32_bf16 v[32:35], v[200:203], v[236:239], v[32:35]
  ds_read_b64_tr_b16 v[196:197], v11 offset:32768
  buffer_load_dwordx4 v3, s[20:23], s11 offen offset:1024 lds
  v_mfma_f32_16x16x32_bf16 v[36:39], v[200:203], v[240:243], v[36:39]
  ds_read_b64_tr_b16 v[198:199], v11 offset:36864
  v_mfma_f32_16x16x32_bf16 v[40:43], v[204:207], v[228:231], v[40:43]
  ds_read_b128 v[156:159], v7 offset:0
  v_mfma_f32_16x16x32_bf16 v[44:47], v[204:207], v[232:235], v[44:47]
  ds_read_b128 v[160:163], v7 offset:1024
  v_mfma_f32_16x16x32_bf16 v[48:51], v[204:207], v[236:239], v[48:51]
  ds_read_b128 v[164:167], v7 offset:2048
  v_mfma_f32_16x16x32_bf16 v[52:55], v[204:207], v[240:243], v[52:55]
  ds_read_b128 v[168:171], v7 offset:3072
  buffer_load_dwordx4 v3, s[20:23], s11 offen offset:2048 lds
  v_mfma_f32_16x16x32_bf16 v[56:59], v[208:211], v[228:231], v[56:59]
  ds_read_b128 v[172:175], v7 offset:4096
  v_mfma_f32_16x16x32_bf16 v[60:63], v[208:211], v[232:235], v[60:63]
  ds_read_b128 v[176:179], v7 offset:5120
  v_mfma_f32_16x16x32_bf16 v[64:67], v[208:211], v[236:239], v[64:67]
  ds_read_b128 v[180:183], v7 offset:6144
  v_mfma_f32_16x16x32_bf16 v[68:71], v[208:211], v[240:243], v[68:71]
  v_mfma_f32_16x16x32_bf16 v[72:75], v[212:215], v[228:231], v[72:75]
  buffer_store_dwordx4 v[244:247], v20, s[20:23], s32 offen sc1
  v_mfma_f32_16x16x32_bf16 v[76:79], v[212:215], v[232:235], v[76:79]
  v_mfma_f32_16x16x32_bf16 v[80:83], v[212:215], v[236:239], v[80:83]
  v_mfma_f32_16x16x32_bf16 v[84:87], v[212:215], v[240:243], v[84:87]
  v_mfma_f32_16x16x32_bf16 v[88:91], v[216:219], v[228:231], v[88:91]
  buffer_load_dwordx4 v3, s[20:23], s11 offen offset:3072 lds
  s_add_u32 s11, s11, 16384
  v_mfma_f32_16x16x32_bf16 v[92:95], v[216:219], v[232:235], v[92:95]
  v_mfma_f32_16x16x32_bf16 v[96:99], v[216:219], v[236:239], v[96:99]
  v_mfma_f32_16x16x32_bf16 v[100:103], v[216:219], v[240:243], v[100:103]
  v_mfma_f32_16x16x32_bf16 v[104:107], v[220:223], v[228:231], v[104:107]
  v_mfma_f32_16x16x32_bf16 v[108:111], v[220:223], v[232:235], v[108:111]
  s_add_u32 m0, s8, 28672
  s_nop 0
  buffer_load_dwordx4 v3, s[20:23], s9 offen offset:0 lds
  v_mfma_f32_16x16x32_bf16 v[112:115], v[220:223], v[236:239], v[112:115]
  v_mfma_f32_16x16x32_bf16 v[116:119], v[220:223], v[240:243], v[116:119]
  v_mfma_f32_16x16x32_bf16 v[120:123], v[224:227], v[228:231], v[120:123]
  v_mfma_f32_16x16x32_bf16 v[124:127], v[224:227], v[232:235], v[124:127]
  buffer_load_dwordx4 v3, s[20:23], s9 offen offset:1024 lds
  v_mfma_f32_16x16x32_bf16 v[128:131], v[224:227], v[236:239], v[128:131]
  v_mfma_f32_16x16x32_bf16 v[132:135], v[224:227], v[240:243], v[132:135]
  s_waitcnt lgkmcnt(13)
  v_mfma_f32_16x16x32_bf16 v[136:139], v[152:155], v[184:187], v[136:139]
  ds_read_b64_tr_b16 v[228:229], v8 offset:40960
  v_mfma_f32_16x16x32_bf16 v[144:147], v[184:187], v[184:187], v[144:147]
  ds_read_b64_tr_b16 v[230:231], v8 offset:45056
  s_waitcnt lgkmcnt(13)
  v_mfma_f32_16x16x32_bf16 v[140:143], v[152:155], v[188:191], v[140:143]
  ds_read_b64_tr_b16 v[232:233], v9 offset:40960
  buffer_load_dwordx4 v3, s[20:23], s9 offen offset:2048 lds
  v_mfma_f32_16x16x32_bf16 v[148:151], v[188:191], v[188:191], v[148:151]
  ds_read_b64_tr_b16 v[234:235], v9 offset:45056
  s_waitcnt lgkmcnt(10)
  v_mfma_f32_16x16x32_bf16 v[24:27], v[156:159], v[184:187], v[24:27]
  ds_read_b64_tr_b16 v[236:237], v10 offset:40960
  v_mfma_f32_16x16x32_bf16 v[28:31], v[156:159], v[188:191], v[28:31]
  ds_read_b64_tr_b16 v[238:239], v10 offset:45056
  v_mfma_f32_16x16x32_bf16 v[32:35], v[156:159], v[192:195], v[32:35]
  ds_read_b64_tr_b16 v[240:241], v11 offset:40960
  buffer_store_dwordx4 v[244:247], v20, s[20:23], s33 offen sc1
  v_mfma_f32_16x16x32_bf16 v[36:39], v[156:159], v[196:199], v[36:39]
  ds_read_b64_tr_b16 v[242:243], v11 offset:45056
  s_waitcnt lgkmcnt(13)
  v_mfma_f32_16x16x32_bf16 v[40:43], v[160:163], v[184:187], v[40:43]
  ds_read_b128 v[200:203], v7 offset:14336
  v_mfma_f32_16x16x32_bf16 v[44:47], v[160:163], v[188:191], v[44:47]
  ds_read_b128 v[204:207], v7 offset:15360
  v_mfma_f32_16x16x32_bf16 v[48:51], v[160:163], v[192:195], v[48:51]
  ds_read_b128 v[208:211], v7 offset:16384
  v_mfma_f32_16x16x32_bf16 v[52:55], v[160:163], v[196:199], v[52:55]
  ds_read_b128 v[212:215], v7 offset:17408
  buffer_load_dwordx4 v3, s[20:23], s9 offen offset:3072 lds
  s_waitcnt lgkmcnt(15)
  v_mfma_f32_16x16x32_bf16 v[56:59], v[164:167], v[184:187], v[56:59]
  ds_read_b128 v[216:219], v7 offset:18432
  v_mfma_f32_16x16x32_bf16 v[60:63], v[164:167], v[188:191], v[60:63]
  ds_read_b128 v[220:223], v7 offset:19456
  v_mfma_f32_16x16x32_bf16 v[64:67], v[164:167], v[192:195], v[64:67]
  ds_read_b128 v[224:227], v7 offset:20480
  v_mfma_f32_16x16x32_bf16 v[68:71], v[164:167], v[196:199], v[68:71]
  v_mfma_f32_16x16x32_bf16 v[72:75], v[168:171], v[184:187], v[72:75]
  s_add_u32 m0, s8, 32768
  s_nop 0
  buffer_load_dwordx4 v4, s[20:23], s9 offen offset:0 lds
  v_mfma_f32_16x16x32_bf16 v[76:79], v[168:171], v[188:191], v[76:79]
  v_mfma_f32_16x16x32_bf16 v[80:83], v[168:171], v[192:195], v[80:83]
  v_mfma_f32_16x16x32_bf16 v[84:87], v[168:171], v[196:199], v[84:87]
  s_waitcnt lgkmcnt(15)
  v_mfma_f32_16x16x32_bf16 v[88:91], v[172:175], v[184:187], v[88:91]
  buffer_load_dwordx4 v4, s[20:23], s9 offen offset:1024 lds
  v_mfma_f32_16x16x32_bf16 v[92:95], v[172:175], v[188:191], v[92:95]
  v_mfma_f32_16x16x32_bf16 v[96:99], v[172:175], v[192:195], v[96:99]
  v_mfma_f32_16x16x32_bf16 v[100:103], v[172:175], v[196:199], v[100:103]
  v_mfma_f32_16x16x32_bf16 v[104:107], v[176:179], v[184:187], v[104:107]
  v_mfma_f32_16x16x32_bf16 v[108:111], v[176:179], v[188:191], v[108:111]
  buffer_store_dwordx4 v[244:247], v3, s[20:23], s30 offen offset:0 sc1
  v_mfma_f32_16x16x32_bf16 v[112:115], v[176:179], v[192:195], v[112:115]
  v_mfma_f32_16x16x32_bf16 v[116:119], v[176:179], v[196:199], v[116:119]
  v_mfma_f32_16x16x32_bf16 v[120:123], v[180:183], v[184:187], v[120:123]
  v_mfma_f32_16x16x32_bf16 v[124:127], v[180:183], v[188:191], v[124:127]
  buffer_load_dwordx4 v4, s[20:23], s9 offen offset:2048 lds
  s_add_u32 s9, s9, 28672
  v_mfma_f32_16x16x32_bf16 v[128:131], v[180:183], v[192:195], v[128:131]
  v_mfma_f32_16x16x32_bf16 v[132:135], v[180:183], v[196:199], v[132:135]
  s_waitcnt lgkmcnt(0)
  s_waitcnt vmcnt(14)
  s_barrier
  v_mfma_f32_16x16x32_bf16 v[136:139], v[152:155], v[228:231], v[136:139]
  ds_read_b64_tr_b16 v[184:185], v8 offset:0
  v_mfma_f32_16x16x32_bf16 v[144:147], v[228:231], v[228:231], v[144:147]
  ds_read_b64_tr_b16 v[186:187], v8 offset:4096
  v_mfma_f32_16x16x32_bf16 v[140:143], v[152:155], v[232:235], v[140:143]
  ds_read_b64_tr_b16 v[188:189], v9 offset:0
  s_add_u32 m0, s10, 32768
  s_nop 0
  buffer_load_dwordx4 v3, s[20:23], s11 offen offset:0 lds
  v_mfma_f32_16x16x32_bf16 v[148:151], v[232:235], v[232:235], v[148:151]
  ds_read_b64_tr_b16 v[190:191], v9 offset:4096
  v_mfma_f32_16x16x32_bf16 v[24:27], v[200:203], v[228:231], v[24:27]
  ds_read_b64_tr_b16 v[192:193], v10 offset:0
  v_mfma_f32_16x16x32_bf16 v[28:31], v[200:203], v[232:235], v[28:31]
  ds_read_b64_tr_b16 v[194:195], v10 offset:4096
  v_mfma_f32_16x16x32_bf16 v[32:35], v[200:203], v[236:239], v[32:35]
  ds_read_b64_tr_b16 v[196:197], v11 offset:0
  buffer_load_dwordx4 v3, s[20:23], s11 offen offset:1024 lds
  v_mfma_f32_16x16x32_bf16 v[36:39], v[200:203], v[240:243], v[36:39]
  ds_read_b64_tr_b16 v[198:199], v11 offset:4096
  v_mfma_f32_16x16x32_bf16 v[40:43], v[204:207], v[228:231], v[40:43]
  ds_read_b128 v[156:159], v6 offset:0
  v_mfma_f32_16x16x32_bf16 v[44:47], v[204:207], v[232:235], v[44:47]
  ds_read_b128 v[160:163], v6 offset:1024
  v_mfma_f32_16x16x32_bf16 v[48:51], v[204:207], v[236:239], v[48:51]
  ds_read_b128 v[164:167], v6 offset:2048
  v_mfma_f32_16x16x32_bf16 v[52:55], v[204:207], v[240:243], v[52:55]
  ds_read_b128 v[168:171], v6 offset:3072
  buffer_load_dwordx4 v3, s[20:23], s11 offen offset:2048 lds
  v_mfma_f32_16x16x32_bf16 v[56:59], v[208:211], v[228:231], v[56:59]
  ds_read_b128 v[172:175], v6 offset:4096
  v_mfma_f32_16x16x32_bf16 v[60:63], v[208:211], v[232:235], v[60:63]
  ds_read_b128 v[176:179], v6 offset:5120
  v_mfma_f32_16x16x32_bf16 v[64:67], v[208:211], v[236:239], v[64:67]
  ds_read_b128 v[180:183], v6 offset:6144
  v_mfma_f32_16x16x32_bf16 v[68:71], v[208:211], v[240:243], v[68:71]
  v_mfma_f32_16x16x32_bf16 v[72:75], v[212:215], v[228:231], v[72:75]
  buffer_store_dwordx4 v[244:247], v3, s[20:23], s30 offen offset:1024 sc1
  v_mfma_f32_16x16x32_bf16 v[76:79], v[212:215], v[232:235], v[76:79]
  v_mfma_f32_16x16x32_bf16 v[80:83], v[212:215], v[236:239], v[80:83]
  v_mfma_f32_16x16x32_bf16 v[84:87], v[212:215], v[240:243], v[84:87]
  v_mfma_f32_16x16x32_bf16 v[88:91], v[216:219], v[228:231], v[88:91]
  buffer_load_dwordx4 v3, s[20:23], s11 offen offset:3072 lds
  s_add_u32 s11, s11, 16384
  v_mfma_f32_16x16x32_bf16 v[92:95], v[216:219], v[232:235], v[92:95]
  v_mfma_f32_16x16x32_bf16 v[96:99], v[216:219], v[236:239], v[96:99]
  v_mfma_f32_16x16x32_bf16 v[100:103], v[216:219], v[240:243], v[100:103]
  v_mfma_f32_16x16x32_bf16 v[104:107], v[220:223], v[228:231], v[104:107]
  v_mfma_f32_16x16x32_bf16 v[108:111], v[220:223], v[232:235], v[108:111]
  s_add_u32 m0, s8, 57344
  s_nop 0
  buffer_load_dwordx4 v3, s[20:23], s9 offen offset:0 lds
  v_mfma_f32_16x16x32_bf16 v[112:115], v[220:223], v[236:239], v[112:115]
  v_mfma_f32_16x16x32_bf16 v[116:119], v[220:223], v[240:243], v[116:119]
  v_mfma_f32_16x16x32_bf16 v[120:123], v[224:227], v[228:231], v[120:123]
  v_mfma_f32_16x16x32_bf16 v[124:127], v[224:227], v[232:235], v[124:127]
  buffer_load_dwordx4 v3, s[20:23], s9 offen offset:1024 lds
  v_mfma_f32_16x16x32_bf16 v[128:131], v[224:227], v[236:239], v[128:131]
  v_mfma_f32_16x16x32_bf16 v[132:135], v[224:227], v[240:243], v[132:135]
  s_waitcnt lgkmcnt(13)
  v_mfma_f32_16x16x32_bf16 v[136:139], v[152:155], v[184:187], v[136:139]
  ds_read_b64_tr_b16 v[228:229], v8 offset:8192
  v_mfma_f32_16x16x32_bf16 v[144:147], v[184:187], v[184:187], v[144:147]
  ds_read_b64_tr_b16 v[230:231], v8 offset:12288
  s_waitcnt lgkmcnt(13)
  v_mfma_f32_16x16x32_bf16 v[140:143], v[152:155], v[188:191], v[140:143]
  ds_read_b64_tr_b16 v[232:233], v9 offset:8192
  buffer_load_dwordx4 v3, s[20:23], s9 offen offset:2048 lds
  v_mfma_f32_16x16x32_bf16 v[148:151], v[188:191], v[188:191], v[148:151]
  ds_read_b64_tr_b16 v[234:235], v9 offset:12288
  s_waitcnt lgkmcnt(10)
  v_mfma_f32_16x16x32_bf16 v[24:27], v[156:159], v[184:187], v[24:27]
  ds_read_b64_tr_b16 v[236:237], v10 offset:8192
  v_mfma_f32_16x16x32_bf16 v[28:31], v[156:159], v[188:191], v[28:31]
  ds_read_b64_tr_b16 v[238:239], v10 offset:12288
  v_mfma_f32_16x16x32_bf16 v[32:35], v[156:159], v[192:195], v[32:35]
  ds_read_b64_tr_b16 v[240:241], v11 offset:8192
  buffer_store_dwordx4 v[244:247], v3, s[20:23], s31 offen offset:0 sc1
  v_mfma_f32_16x16x32_bf16 v[36:39], v[156:159], v[196:199], v[36:39]
  ds_read_b64_tr_b16 v[242:243], v11 offset:12288
  s_waitcnt lgkmcnt(13)
  v_mfma_f32_16x16x32_bf16 v[40:43], v[160:163], v[184:187], v[40:43]
  ds_read_b128 v[200:203], v6 offset:14336
  v_mfma_f32_16x16x32_bf16 v[44:47], v[160:163], v[188:191], v[44:47]
  ds_read_b128 v[204:207], v6 offset:15360
  v_mfma_f32_16x16x32_bf16 v[48:51], v[160:163], v[192:195], v[48:51]
  ds_read_b128 v[208:211], v6 offset:16384
  v_mfma_f32_16x16x32_bf16 v[52:55], v[160:163], v[196:199], v[52:55]
  ds_read_b128 v[212:215], v6 offset:17408
  buffer_load_dwordx4 v3, s[20:23], s9 offen offset:3072 lds
  s_waitcnt lgkmcnt(15)
  v_mfma_f32_16x16x32_bf16 v[56:59], v[164:167], v[184:187], v[56:59]
  ds_read_b128 v[216:219], v6 offset:18432
  v_mfma_f32_16x16x32_bf16 v[60:63], v[164:167], v[188:191], v[60:63]
  ds_read_b128 v[220:223], v6 offset:19456
  v_mfma_f32_16x16x32_bf16 v[64:67], v[164:167], v[192:195], v[64:67]
  ds_read_b128 v[224:227], v6 offset:20480
  v_mfma_f32_16x16x32_bf16 v[68:71], v[164:167], v[196:199], v[68:71]
  v_mfma_f32_16x16x32_bf16 v[72:75], v[168:171], v[184:187], v[72:75]
  s_add_u32 m0, s8, 61440
  s_nop 0
  buffer_load_dwordx4 v4, s[20:23], s9 offen offset:0 lds
  v_mfma_f32_16x16x32_bf16 v[76:79], v[168:171], v[188:191], v[76:79]
  v_add_f32 v249, v249, v250
  v_mfma_f32_16x16x32_bf16 v[80:83], v[168:171], v[192:195], v[80:83]
  v_mfma_f32_16x16x32_bf16 v[84:87], v[168:171], v[196:199], v[84:87]
  v_add_f32 v251, v251, v252
  s_waitcnt lgkmcnt(15)
  v_mfma_f32_16x16x32_bf16 v[88:91], v[172:175], v[184:187], v[88:91]
  buffer_load_dwordx4 v4, s[20:23], s9 offen offset:1024 lds
  v_mfma_f32_16x16x32_bf16 v[92:95], v[172:175], v[188:191], v[92:95]
  v_add_u32 v5, 135168, v5
  v_mfma_f32_16x16x32_bf16 v[96:99], v[172:175], v[192:195], v[96:99]
  v_mfma_f32_16x16x32_bf16 v[100:103], v[172:175], v[196:199], v[100:103]
  v_add_f32 v249, v249, v251
  v_mfma_f32_16x16x32_bf16 v[104:107], v[176:179], v[184:187], v[104:107]
  v_mfma_f32_16x16x32_bf16 v[108:111], v[176:179], v[188:191], v[108:111]
  buffer_store_dwordx4 v[244:247], v3, s[20:23], s31 offen offset:1024 sc1
  ds_write_b32 v5, v249
  v_mfma_f32_16x16x32_bf16 v[112:115], v[176:179], v[192:195], v[112:115]
  v_mfma_f32_16x16x32_bf16 v[116:119], v[176:179], v[196:199], v[116:119]
  v_mfma_f32_16x16x32_bf16 v[120:123], v[180:183], v[184:187], v[120:123]
  v_mfma_f32_16x16x32_bf16 v[124:127], v[180:183], v[188:191], v[124:127]
  buffer_load_dwordx4 v4, s[20:23], s9 offen offset:2048 lds
  s_add_u32 s9, s9, 28672
  v_mfma_f32_16x16x32_bf16 v[128:131], v[180:183], v[192:195], v[128:131]
  v_mfma_f32_16x16x32_bf16 v[132:135], v[180:183], v[196:199], v[132:135]
  s_waitcnt lgkmcnt(0)
  s_waitcnt vmcnt(14)
  s_barrier
  v_mfma_f32_16x16x32_bf16 v[136:139], v[152:155], v[228:231], v[136:139]
  ds_read_b64_tr_b16 v[184:185], v8 offset:16384
  v_mfma_f32_16x16x32_bf16 v[144:147], v[228:231], v[228:231], v[144:147]
  ds_read_b64_tr_b16 v[186:187], v8 offset:20480
  v_mfma_f32_16x16x32_bf16 v[140:143], v[152:155], v[232:235], v[140:143]
  ds_read_b64_tr_b16 v[188:189], v9 offset:16384
  s_add_u32 m0, s10, 0
  s_nop 0
  buffer_load_dwordx4 v3, s[20:23], s11 offen offset:0 lds
  v_mfma_f32_16x16x32_bf16 v[148:151], v[232:235], v[232:235], v[148:151]
  ds_read_b64_tr_b16 v[190:191], v9 offset:20480
  v_mfma_f32_16x16x32_bf16 v[24:27], v[200:203], v[228:231], v[24:27]
  ds_read_b64_tr_b16 v[192:193], v10 offset:16384
  v_mfma_f32_16x16x32_bf16 v[28:31], v[200:203], v[232:235], v[28:31]
  ds_read_b64_tr_b16 v[194:195], v10 offset:20480
  v_mfma_f32_16x16x32_bf16 v[32:35], v[200:203], v[236:239], v[32:35]
  ds_read_b64_tr_b16 v[196:197], v11 offset:16384
  buffer_load_dwordx4 v3, s[20:23], s11 offen offset:1024 lds
  v_mfma_f32_16x16x32_bf16 v[36:39], v[200:203], v[240:243], v[36:39]
  ds_read_b64_tr_b16 v[198:199], v11 offset:20480
  v_mfma_f32_16x16x32_bf16 v[40:43], v[204:207], v[228:231], v[40:43]
  ds_read_b128 v[156:159], v6 offset:28672
  v_mfma_f32_16x16x32_bf16 v[44:47], v[204:207], v[232:235], v[44:47]
  ds_read_b128 v[160:163], v6 offset:29696
  v_mfma_f32_16x16x32_bf16 v[48:51], v[204:207], v[236:239], v[48:51]
  ds_read_b128 v[164:167], v6 offset:30720
  v_mfma_f32_16x16x32_bf16 v[52:55], v[204:207], v[240:243], v[52:55]
  ds_read_b128 v[168:171], v6 offset:31744
  buffer_load_dwordx4 v3, s[20:23], s11 offen offset:2048 lds
  v_mfma_f32_16x16x32_bf16 v[56:59], v[208:211], v[228:231], v[56:59]
  ds_read_b128 v[172:175], v6 offset:32768
  v_mfma_f32_16x16x32_bf16 v[60:63], v[208:211], v[232:235], v[60:63]
  ds_read_b128 v[176:179], v6 offset:33792
  v_mfma_f32_16x16x32_bf16 v[64:67], v[208:211], v[236:239], v[64:67]
  ds_read_b128 v[180:183], v6 offset:34816
  v_mfma_f32_16x16x32_bf16 v[68:71], v[208:211], v[240:243], v[68:71]
  v_mfma_f32_16x16x32_bf16 v[72:75], v[212:215], v[228:231], v[72:75]
  buffer_load_dwordx4 a[0:3], v3, s[40:43], s54 offen
  v_mfma_f32_16x16x32_bf16 v[76:79], v[212:215], v[232:235], v[76:79]
  v_mfma_f32_16x16x32_bf16 v[80:83], v[212:215], v[236:239], v[80:83]
  v_mfma_f32_16x16x32_bf16 v[84:87], v[212:215], v[240:243], v[84:87]
  v_mfma_f32_16x16x32_bf16 v[88:91], v[216:219], v[228:231], v[88:91]
  buffer_load_dwordx4 v3, s[20:23], s11 offen offset:3072 lds
  s_add_u32 s11, s11, 16384
  v_mfma_f32_16x16x32_bf16 v[92:95], v[216:219], v[232:235], v[92:95]
  v_mfma_f32_16x16x32_bf16 v[96:99], v[216:219], v[236:239], v[96:99]
  v_mfma_f32_16x16x32_bf16 v[100:103], v[216:219], v[240:243], v[100:103]
  v_mfma_f32_16x16x32_bf16 v[104:107], v[220:223], v[228:231], v[104:107]
  v_mfma_f32_16x16x32_bf16 v[108:111], v[220:223], v[232:235], v[108:111]
  s_add_u32 m0, s8, 0
  s_nop 0
  buffer_load_dwordx4 v3, s[20:23], s9 offen offset:0 lds
  v_mfma_f32_16x16x32_bf16 v[112:115], v[220:223], v[236:239], v[112:115]
  v_mfma_f32_16x16x32_bf16 v[116:119], v[220:223], v[240:243], v[116:119]
  v_mfma_f32_16x16x32_bf16 v[120:123], v[224:227], v[228:231], v[120:123]
  v_mfma_f32_16x16x32_bf16 v[124:127], v[224:227], v[232:235], v[124:127]
  buffer_load_dwordx4 v3, s[20:23], s9 offen offset:1024 lds
  v_mfma_f32_16x16x32_bf16 v[128:131], v[224:227], v[236:239], v[128:131]
  v_mfma_f32_16x16x32_bf16 v[132:135], v[224:227], v[240:243], v[132:135]
  s_waitcnt lgkmcnt(13)
  v_mfma_f32_16x16x32_bf16 v[136:139], v[152:155], v[184:187], v[136:139]
  ds_read_b64_tr_b16 v[228:229], v8 offset:24576
  v_mfma_f32_16x16x32_bf16 v[144:147], v[184:187], v[184:187], v[144:147]
  ds_read_b64_tr_b16 v[230:231], v8 offset:28672
  s_waitcnt lgkmcnt(13)
  v_mfma_f32_16x16x32_bf16 v[140:143], v[152:155], v[188:191], v[140:143]
  ds_read_b64_tr_b16 v[232:233], v9 offset:24576
  buffer_load_dwordx4 v3, s[20:23], s9 offen offset:2048 lds
  v_mfma_f32_16x16x32_bf16 v[148:151], v[188:191], v[188:191], v[148:151]
  ds_read_b64_tr_b16 v[234:235], v9 offset:28672
  s_waitcnt lgkmcnt(10)
  v_mfma_f32_16x16x32_bf16 v[24:27], v[156:159], v[184:187], v[24:27]
  ds_read_b64_tr_b16 v[236:237], v10 offset:24576
  v_mfma_f32_16x16x32_bf16 v[28:31], v[156:159], v[188:191], v[28:31]
  ds_read_b64_tr_b16 v[238:239], v10 offset:28672
  v_mfma_f32_16x16x32_bf16 v[32:35], v[156:159], v[192:195], v[32:35]
  ds_read_b64_tr_b16 v[240:241], v11 offset:24576
  buffer_load_dwordx4 a[4:7], v3, s[40:43], s54 offen offset:1024
  v_mfma_f32_16x16x32_bf16 v[36:39], v[156:159], v[196:199], v[36:39]
  ds_read_b64_tr_b16 v[242:243], v11 offset:28672
  s_waitcnt lgkmcnt(13)
  v_mfma_f32_16x16x32_bf16 v[40:43], v[160:163], v[184:187], v[40:43]
  ds_read_b128 v[200:203], v6 offset:43008
  v_mfma_f32_16x16x32_bf16 v[44:47], v[160:163], v[188:191], v[44:47]
  ds_read_b128 v[204:207], v6 offset:44032
  v_mfma_f32_16x16x32_bf16 v[48:51], v[160:163], v[192:195], v[48:51]
  ds_read_b128 v[208:211], v6 offset:45056
  v_mfma_f32_16x16x32_bf16 v[52:55], v[160:163], v[196:199], v[52:55]
  ds_read_b128 v[212:215], v6 offset:46080
  buffer_load_dwordx4 v3, s[20:23], s9 offen offset:3072 lds
  s_waitcnt lgkmcnt(15)
  v_mfma_f32_16x16x32_bf16 v[56:59], v[164:167], v[184:187], v[56:59]
  ds_read_b128 v[216:219], v6 offset:47104
  v_mfma_f32_16x16x32_bf16 v[60:63], v[164:167], v[188:191], v[60:63]
  ds_read_b128 v[220:223], v6 offset:48128
  v_mfma_f32_16x16x32_bf16 v[64:67], v[164:167], v[192:195], v[64:67]
  ds_read_b128 v[224:227], v6 offset:49152
  v_mfma_f32_16x16x32_bf16 v[68:71], v[164:167], v[196:199], v[68:71]
  v_mfma_f32_16x16x32_bf16 v[72:75], v[168:171], v[184:187], v[72:75]
  s_add_u32 m0, s8, 4096
  s_nop 0
  buffer_load_dwordx4 v4, s[20:23], s9 offen offset:0 lds
  v_mfma_f32_16x16x32_bf16 v[76:79], v[168:171], v[188:191], v[76:79]
  v_mfma_f32_16x16x32_bf16 v[80:83], v[168:171], v[192:195], v[80:83]
  v_mfma_f32_16x16x32_bf16 v[84:87], v[168:171], v[196:199], v[84:87]
  s_waitcnt lgkmcnt(15)
  v_mfma_f32_16x16x32_bf16 v[88:91], v[172:175], v[184:187], v[88:91]
  buffer_load_dwordx4 v4, s[20:23], s9 offen offset:1024 lds
  v_mfma_f32_16x16x32_bf16 v[92:95], v[172:175], v[188:191], v[92:95]
  v_mfma_f32_16x16x32_bf16 v[96:99], v[172:175], v[192:195], v[96:99]
  v_mfma_f32_16x16x32_bf16 v[100:103], v[172:175], v[196:199], v[100:103]
  v_mfma_f32_16x16x32_bf16 v[104:107], v[176:179], v[184:187], v[104:107]
  v_mfma_f32_16x16x32_bf16 v[108:111], v[176:179], v[188:191], v[108:111]
  buffer_load_dwordx4 a[8:11], v3, s[40:43], s54 offen offset:2048
  v_mfma_f32_16x16x32_bf16 v[112:115], v[176:179], v[192:195], v[112:115]
  v_mfma_f32_16x16x32_bf16 v[116:119], v[176:179], v[196:199], v[116:119]
  v_mfma_f32_16x16x32_bf16 v[120:123], v[180:183], v[184:187], v[120:123]
  v_mfma_f32_16x16x32_bf16 v[124:127], v[180:183], v[188:191], v[124:127]
  buffer_load_dwordx4 v4, s[20:23], s9 offen offset:2048 lds
  s_add_u32 s9, s9, 28672
  v_mfma_f32_16x16x32_bf16 v[128:131], v[180:183], v[192:195], v[128:131]
  v_mfma_f32_16x16x32_bf16 v[132:135], v[180:183], v[196:199], v[132:135]
  s_waitcnt lgkmcnt(0)
  s_waitcnt vmcnt(14)
  s_barrier
  v_mfma_f32_16x16x32_bf16 v[136:139], v[152:155], v[228:231], v[136:139]
  ds_read_b64_tr_b16 v[184:185], v8 offset:32768
  v_mfma_f32_16x16x32_bf16 v[144:147], v[228:231], v[228:231], v[144:147]
  ds_read_b64_tr_b16 v[186:187], v8 offset:36864
  v_mfma_f32_16x16x32_bf16 v[140:143], v[152:155], v[232:235], v[140:143]
  ds_read_b64_tr_b16 v[188:189], v9 offset:32768
  s_add_u32 m0, s10, 16384
  s_nop 0
  buffer_load_dwordx4 v3, s[20:23], s11 offen offset:0 lds
  v_mfma_f32_16x16x32_bf16 v[148:151], v[232:235], v[232:235], v[148:151]
  ds_read_b64_tr_b16 v[190:191], v9 offset:36864
  v_mfma_f32_16x16x32_bf16 v[24:27], v[200:203], v[228:231], v[24:27]
  ds_read_b64_tr_b16 v[192:193], v10 offset:32768
  v_mfma_f32_16x16x32_bf16 v[28:31], v[200:203], v[232:235], v[28:31]
  ds_read_b64_tr_b16 v[194:195], v10 offset:36864
  v_mfma_f32_16x16x32_bf16 v[32:35], v[200:203], v[236:239], v[32:35]
  ds_read_b64_tr_b16 v[196:197], v11 offset:32768
  buffer_load_dwordx4 v3, s[20:23], s11 offen offset:1024 lds
  v_mfma_f32_16x16x32_bf16 v[36:39], v[200:203], v[240:243], v[36:39]
  ds_read_b64_tr_b16 v[198:199], v11 offset:36864
  v_mfma_f32_16x16x32_bf16 v[40:43], v[204:207], v[228:231], v[40:43]
  ds_read_b128 v[156:159], v7 offset:0
  v_mfma_f32_16x16x32_bf16 v[44:47], v[204:207], v[232:235], v[44:47]
  ds_read_b128 v[160:163], v7 offset:1024
  v_mfma_f32_16x16x32_bf16 v[48:51], v[204:207], v[236:239], v[48:51]
  ds_read_b128 v[164:167], v7 offset:2048
  v_mfma_f32_16x16x32_bf16 v[52:55], v[204:207], v[240:243], v[52:55]
  ds_read_b128 v[168:171], v7 offset:3072
  buffer_load_dwordx4 v3, s[20:23], s11 offen offset:2048 lds
  v_mfma_f32_16x16x32_bf16 v[56:59], v[208:211], v[228:231], v[56:59]
  ds_read_b128 v[172:175], v7 offset:4096
  v_mfma_f32_16x16x32_bf16 v[60:63], v[208:211], v[232:235], v[60:63]
  ds_read_b128 v[176:179], v7 offset:5120
  v_mfma_f32_16x16x32_bf16 v[64:67], v[208:211], v[236:239], v[64:67]
  ds_read_b128 v[180:183], v7 offset:6144
  v_mfma_f32_16x16x32_bf16 v[68:71], v[208:211], v[240:243], v[68:71]
  v_mfma_f32_16x16x32_bf16 v[72:75], v[212:215], v[228:231], v[72:75]
  buffer_load_dwordx4 a[12:15], v3, s[40:43], s54 offen offset:3072
  v_mfma_f32_16x16x32_bf16 v[76:79], v[212:215], v[232:235], v[76:79]
  v_mfma_f32_16x16x32_bf16 v[80:83], v[212:215], v[236:239], v[80:83]
  v_mfma_f32_16x16x32_bf16 v[84:87], v[212:215], v[240:243], v[84:87]
  v_mfma_f32_16x16x32_bf16 v[88:91], v[216:219], v[228:231], v[88:91]
  buffer_load_dwordx4 v3, s[20:23], s11 offen offset:3072 lds
  s_add_u32 s11, s11, 16384
  v_mfma_f32_16x16x32_bf16 v[92:95], v[216:219], v[232:235], v[92:95]
  v_mfma_f32_16x16x32_bf16 v[96:99], v[216:219], v[236:239], v[96:99]
  v_mfma_f32_16x16x32_bf16 v[100:103], v[216:219], v[240:243], v[100:103]
  v_mfma_f32_16x16x32_bf16 v[104:107], v[220:223], v[228:231], v[104:107]
  v_mfma_f32_16x16x32_bf16 v[108:111], v[220:223], v[232:235], v[108:111]
  s_add_u32 m0, s8, 28672
  s_nop 0
  buffer_load_dwordx4 v3, s[20:23], s9 offen offset:0 lds
  v_mfma_f32_16x16x32_bf16 v[112:115], v[220:223], v[236:239], v[112:115]
  v_mfma_f32_16x16x32_bf16 v[116:119], v[220:223], v[240:243], v[116:119]
  v_mfma_f32_16x16x32_bf16 v[120:123], v[224:227], v[228:231], v[120:123]
  v_mfma_f32_16x16x32_bf16 v[124:127], v[224:227], v[232:235], v[124:127]
  buffer_load_dwordx4 v3, s[20:23], s9 offen offset:1024 lds
  v_mfma_f32_16x16x32_bf16 v[128:131], v[224:227], v[236:239], v[128:131]
  v_mfma_f32_16x16x32_bf16 v[132:135], v[224:227], v[240:243], v[132:135]
  s_waitcnt lgkmcnt(13)
  v_mfma_f32_16x16x32_bf16 v[136:139], v[152:155], v[184:187], v[136:139]
  ds_read_b64_tr_b16 v[228:229], v8 offset:40960
  v_mfma_f32_16x16x32_bf16 v[144:147], v[184:187], v[184:187], v[144:147]
  ds_read_b64_tr_b16 v[230:231], v8 offset:45056
  s_waitcnt lgkmcnt(13)
  v_mfma_f32_16x16x32_bf16 v[140:143], v[152:155], v[188:191], v[140:143]
  ds_read_b64_tr_b16 v[232:233], v9 offset:40960
  buffer_load_dwordx4 v3, s[20:23], s9 offen offset:2048 lds
  v_mfma_f32_16x16x32_bf16 v[148:151], v[188:191], v[188:191], v[148:151]
  ds_read_b64_tr_b16 v[234:235], v9 offset:45056
  s_waitcnt lgkmcnt(10)
  v_mfma_f32_16x16x32_bf16 v[24:27], v[156:159], v[184:187], v[24:27]
  ds_read_b64_tr_b16 v[236:237], v10 offset:40960
  v_mfma_f32_16x16x32_bf16 v[28:31], v[156:159], v[188:191], v[28:31]
  ds_read_b64_tr_b16 v[238:239], v10 offset:45056
  v_mfma_f32_16x16x32_bf16 v[32:35], v[156:159], v[192:195], v[32:35]
  ds_read_b64_tr_b16 v[240:241], v11 offset:40960
  buffer_load_dwordx4 a[16:19], v4, s[40:43], s54 offen
  s_add_u32 s54, s54, 143360
  v_mfma_f32_16x16x32_bf16 v[36:39], v[156:159], v[196:199], v[36:39]
  ds_read_b64_tr_b16 v[242:243], v11 offset:45056
  s_waitcnt lgkmcnt(13)
  v_mfma_f32_16x16x32_bf16 v[40:43], v[160:163], v[184:187], v[40:43]
  ds_read_b128 v[200:203], v7 offset:14336
  v_mfma_f32_16x16x32_bf16 v[44:47], v[160:163], v[188:191], v[44:47]
  ds_read_b128 v[204:207], v7 offset:15360
  v_mfma_f32_16x16x32_bf16 v[48:51], v[160:163], v[192:195], v[48:51]
  ds_read_b128 v[208:211], v7 offset:16384
  v_mfma_f32_16x16x32_bf16 v[52:55], v[160:163], v[196:199], v[52:55]
  ds_read_b128 v[212:215], v7 offset:17408
  buffer_load_dwordx4 v3, s[20:23], s9 offen offset:3072 lds
  s_waitcnt lgkmcnt(15)
  v_mfma_f32_16x16x32_bf16 v[56:59], v[164:167], v[184:187], v[56:59]
  ds_read_b128 v[216:219], v7 offset:18432
  v_mfma_f32_16x16x32_bf16 v[60:63], v[164:167], v[188:191], v[60:63]
  ds_read_b128 v[220:223], v7 offset:19456
  v_mfma_f32_16x16x32_bf16 v[64:67], v[164:167], v[192:195], v[64:67]
  ds_read_b128 v[224:227], v7 offset:20480
  v_mfma_f32_16x16x32_bf16 v[68:71], v[164:167], v[196:199], v[68:71]
  v_mfma_f32_16x16x32_bf16 v[72:75], v[168:171], v[184:187], v[72:75]
  s_add_u32 m0, s8, 32768
  s_nop 0
  buffer_load_dwordx4 v4, s[20:23], s9 offen offset:0 lds
  v_mfma_f32_16x16x32_bf16 v[76:79], v[168:171], v[188:191], v[76:79]
  v_mfma_f32_16x16x32_bf16 v[80:83], v[168:171], v[192:195], v[80:83]
  v_mfma_f32_16x16x32_bf16 v[84:87], v[168:171], v[196:199], v[84:87]
  s_waitcnt lgkmcnt(15)
  v_mfma_f32_16x16x32_bf16 v[88:91], v[172:175], v[184:187], v[88:91]
  buffer_load_dwordx4 v4, s[20:23], s9 offen offset:1024 lds
  v_mfma_f32_16x16x32_bf16 v[92:95], v[172:175], v[188:191], v[92:95]
  v_mfma_f32_16x16x32_bf16 v[96:99], v[172:175], v[192:195], v[96:99]
  v_mfma_f32_16x16x32_bf16 v[100:103], v[172:175], v[196:199], v[100:103]
  v_mfma_f32_16x16x32_bf16 v[104:107], v[176:179], v[184:187], v[104:107]
  v_mfma_f32_16x16x32_bf16 v[108:111], v[176:179], v[188:191], v[108:111]
  buffer_load_dwordx4 a[20:23], v3, s[40:43], s54 offen
  v_mfma_f32_16x16x32_bf16 v[112:115], v[176:179], v[192:195], v[112:115]
  v_mfma_f32_16x16x32_bf16 v[116:119], v[176:179], v[196:199], v[116:119]
  v_mfma_f32_16x16x32_bf16 v[120:123], v[180:183], v[184:187], v[120:123]
  v_mfma_f32_16x16x32_bf16 v[124:127], v[180:183], v[188:191], v[124:127]
  buffer_load_dwordx4 v4, s[20:23], s9 offen offset:2048 lds
  s_add_u32 s9, s9, 28672
  v_mfma_f32_16x16x32_bf16 v[128:131], v[180:183], v[192:195], v[128:131]
  v_mfma_f32_16x16x32_bf16 v[132:135], v[180:183], v[196:199], v[132:135]
  s_waitcnt lgkmcnt(0)
  s_waitcnt vmcnt(14)
  s_barrier
  v_mfma_f32_16x16x32_bf16 v[136:139], v[152:155], v[228:231], v[136:139]
  ds_read_b64_tr_b16 v[184:185], v8 offset:0
  v_mfma_f32_16x16x32_bf16 v[144:147], v[228:231], v[228:231], v[144:147]
  ds_read_b64_tr_b16 v[186:187], v8 offset:4096
  v_mfma_f32_16x16x32_bf16 v[140:143], v[152:155], v[232:235], v[140:143]
  ds_read_b64_tr_b16 v[188:189], v9 offset:0
  s_add_u32 m0, s10, 32768
  s_nop 0
  buffer_load_dwordx4 v3, s[20:23], s11 offen offset:0 lds
  v_mfma_f32_16x16x32_bf16 v[148:151], v[232:235], v[232:235], v[148:151]
  ds_read_b64_tr_b16 v[190:191], v9 offset:4096
  v_mfma_f32_16x16x32_bf16 v[24:27], v[200:203], v[228:231], v[24:27]
  ds_read_b64_tr_b16 v[192:193], v10 offset:0
  v_mfma_f32_16x16x32_bf16 v[28:31], v[200:203], v[232:235], v[28:31]
  ds_read_b64_tr_b16 v[194:195], v10 offset:4096
  v_mfma_f32_16x16x32_bf16 v[32:35], v[200:203], v[236:239], v[32:35]
  ds_read_b64_tr_b16 v[196:197], v11 offset:0
  buffer_load_dwordx4 v3, s[20:23], s11 offen offset:1024 lds
  v_mfma_f32_16x16x32_bf16 v[36:39], v[200:203], v[240:243], v[36:39]
  ds_read_b64_tr_b16 v[198:199], v11 offset:4096
  v_mfma_f32_16x16x32_bf16 v[40:43], v[204:207], v[228:231], v[40:43]
  ds_read_b128 v[156:159], v6 offset:0
  v_mfma_f32_16x16x32_bf16 v[44:47], v[204:207], v[232:235], v[44:47]
  ds_read_b128 v[160:163], v6 offset:1024
  v_mfma_f32_16x16x32_bf16 v[48:51], v[204:207], v[236:239], v[48:51]
  ds_read_b128 v[164:167], v6 offset:2048
  v_mfma_f32_16x16x32_bf16 v[52:55], v[204:207], v[240:243], v[52:55]
  ds_read_b128 v[168:171], v6 offset:3072
  buffer_load_dwordx4 v3, s[20:23], s11 offen offset:2048 lds
  v_mfma_f32_16x16x32_bf16 v[56:59], v[208:211], v[228:231], v[56:59]
  ds_read_b128 v[172:175], v6 offset:4096
  v_mfma_f32_16x16x32_bf16 v[60:63], v[208:211], v[232:235], v[60:63]
  ds_read_b128 v[176:179], v6 offset:5120
  v_mfma_f32_16x16x32_bf16 v[64:67], v[208:211], v[236:239], v[64:67]
  ds_read_b128 v[180:183], v6 offset:6144
  v_mfma_f32_16x16x32_bf16 v[68:71], v[208:211], v[240:243], v[68:71]
  v_mfma_f32_16x16x32_bf16 v[72:75], v[212:215], v[228:231], v[72:75]
  buffer_load_dwordx4 a[24:27], v3, s[40:43], s54 offen offset:1024
  v_mfma_f32_16x16x32_bf16 v[76:79], v[212:215], v[232:235], v[76:79]
  v_mfma_f32_16x16x32_bf16 v[80:83], v[212:215], v[236:239], v[80:83]
  v_mfma_f32_16x16x32_bf16 v[84:87], v[212:215], v[240:243], v[84:87]
  v_mfma_f32_16x16x32_bf16 v[88:91], v[216:219], v[228:231], v[88:91]
  buffer_load_dwordx4 v3, s[20:23], s11 offen offset:3072 lds
  s_add_u32 s11, s11, 16384
  v_mfma_f32_16x16x32_bf16 v[92:95], v[216:219], v[232:235], v[92:95]
  v_mfma_f32_16x16x32_bf16 v[96:99], v[216:219], v[236:239], v[96:99]
  v_mfma_f32_16x16x32_bf16 v[100:103], v[216:219], v[240:243], v[100:103]
  v_mfma_f32_16x16x32_bf16 v[104:107], v[220:223], v[228:231], v[104:107]
  v_mfma_f32_16x16x32_bf16 v[108:111], v[220:223], v[232:235], v[108:111]
  s_add_u32 m0, s8, 57344
  s_nop 0
  buffer_load_dwordx4 v3, s[20:23], s9 offen offset:0 lds
  v_mfma_f32_16x16x32_bf16 v[112:115], v[220:223], v[236:239], v[112:115]
  v_mfma_f32_16x16x32_bf16 v[116:119], v[220:223], v[240:243], v[116:119]
  v_mfma_f32_16x16x32_bf16 v[120:123], v[224:227], v[228:231], v[120:123]
  v_mfma_f32_16x16x32_bf16 v[124:127], v[224:227], v[232:235], v[124:127]
  buffer_load_dwordx4 v3, s[20:23], s9 offen offset:1024 lds
  v_mfma_f32_16x16x32_bf16 v[128:131], v[224:227], v[236:239], v[128:131]
  v_mfma_f32_16x16x32_bf16 v[132:135], v[224:227], v[240:243], v[132:135]
  s_waitcnt lgkmcnt(13)
  v_mfma_f32_16x16x32_bf16 v[136:139], v[152:155], v[184:187], v[136:139]
  ds_read_b64_tr_b16 v[228:229], v8 offset:8192
  v_mfma_f32_16x16x32_bf16 v[144:147], v[184:187], v[184:187], v[144:147]
  ds_read_b64_tr_b16 v[230:231], v8 offset:12288
  s_waitcnt lgkmcnt(13)
  v_mfma_f32_16x16x32_bf16 v[140:143], v[152:155], v[188:191], v[140:143]
  ds_read_b64_tr_b16 v[232:233], v9 offset:8192
  buffer_load_dwordx4 v3, s[20:23], s9 offen offset:2048 lds
  v_mfma_f32_16x16x32_bf16 v[148:151], v[188:191], v[188:191], v[148:151]
  ds_read_b64_tr_b16 v[234:235], v9 offset:12288
  s_waitcnt lgkmcnt(10)
  v_mfma_f32_16x16x32_bf16 v[24:27], v[156:159], v[184:187], v[24:27]
  ds_read_b64_tr_b16 v[236:237], v10 offset:8192
  v_mfma_f32_16x16x32_bf16 v[28:31], v[156:159], v[188:191], v[28:31]
  ds_read_b64_tr_b16 v[238:239], v10 offset:12288
  v_mfma_f32_16x16x32_bf16 v[32:35], v[156:159], v[192:195], v[32:35]
  ds_read_b64_tr_b16 v[240:241], v11 offset:8192
  buffer_load_dwordx4 a[28:31], v3, s[40:43], s54 offen offset:2048
  v_mfma_f32_16x16x32_bf16 v[36:39], v[156:159], v[196:199], v[36:39]
  ds_read_b64_tr_b16 v[242:243], v11 offset:12288
  s_waitcnt lgkmcnt(13)
  v_mfma_f32_16x16x32_bf16 v[40:43], v[160:163], v[184:187], v[40:43]
  ds_read_b128 v[200:203], v6 offset:14336
  v_mfma_f32_16x16x32_bf16 v[44:47], v[160:163], v[188:191], v[44:47]
  ds_read_b128 v[204:207], v6 offset:15360
  v_mfma_f32_16x16x32_bf16 v[48:51], v[160:163], v[192:195], v[48:51]
  ds_read_b128 v[208:211], v6 offset:16384
  buffer_load_dwordx4 v3, s[20:23], s9 offen offset:3072 lds
  v_mfma_f32_16x16x32_bf16 v[52:55], v[160:163], v[196:199], v[52:55]
  ds_read_b128 v[212:215], v6 offset:17408
  s_waitcnt lgkmcnt(15)
  v_mfma_f32_16x16x32_bf16 v[56:59], v[164:167], v[184:187], v[56:59]
  ds_read_b128 v[216:219], v6 offset:18432
  v_mfma_f32_16x16x32_bf16 v[60:63], v[164:167], v[188:191], v[60:63]
  ds_read_b128 v[220:223], v6 offset:19456
  v_mfma_f32_16x16x32_bf16 v[64:67], v[164:167], v[192:195], v[64:67]
  ds_read_b128 v[224:227], v6 offset:20480
  s_add_u32 m0, s8, 61440
  s_nop 0
  buffer_load_dwordx4 v4, s[20:23], s9 offen offset:0 lds
  v_mfma_f32_16x16x32_bf16 v[68:71], v[164:167], v[196:199], v[68:71]
  v_mfma_f32_16x16x32_bf16 v[72:75], v[168:171], v[184:187], v[72:75]
  v_mfma_f32_16x16x32_bf16 v[76:79], v[168:171], v[188:191], v[76:79]
  v_mfma_f32_16x16x32_bf16 v[80:83], v[168:171], v[192:195], v[80:83]
  buffer_load_dwordx4 a[32:35], v3, s[40:43], s54 offen offset:3072
  v_mfma_f32_16x16x32_bf16 v[84:87], v[168:171], v[196:199], v[84:87]
  s_waitcnt lgkmcnt(15)
  v_mfma_f32_16x16x32_bf16 v[88:91], v[172:175], v[184:187], v[88:91]
  v_mfma_f32_16x16x32_bf16 v[92:95], v[172:175], v[188:191], v[92:95]
  v_mfma_f32_16x16x32_bf16 v[96:99], v[172:175], v[192:195], v[96:99]
  buffer_load_dwordx4 v4, s[20:23], s9 offen offset:1024 lds
  v_mfma_f32_16x16x32_bf16 v[100:103], v[172:175], v[196:199], v[100:103]
  v_mfma_f32_16x16x32_bf16 v[104:107], v[176:179], v[184:187], v[104:107]
  v_mfma_f32_16x16x32_bf16 v[108:111], v[176:179], v[188:191], v[108:111]
  v_mfma_f32_16x16x32_bf16 v[112:115], v[176:179], v[192:195], v[112:115]
  s_mov_b64 exec, 1
  buffer_store_dword v152, v22, s[20:23], s36 offen sc1
  s_mov_b64 exec, -1
  v_mfma_f32_16x16x32_bf16 v[116:119], v[176:179], v[196:199], v[116:119]
  v_mfma_f32_16x16x32_bf16 v[120:123], v[180:183], v[184:187], v[120:123]
  v_mfma_f32_16x16x32_bf16 v[124:127], v[180:183], v[188:191], v[124:127]
  v_mfma_f32_16x16x32_bf16 v[128:131], v[180:183], v[192:195], v[128:131]
  buffer_load_dwordx4 v4, s[20:23], s9 offen offset:2048 lds
  s_add_u32 s9, s9, 28672
  v_mfma_f32_16x16x32_bf16 v[132:135], v[180:183], v[196:199], v[132:135]
  s_waitcnt lgkmcnt(0)
  s_waitcnt vmcnt(15)
  s_barrier
  v_mfma_f32_16x16x32_bf16 v[136:139], v[152:155], v[228:231], v[136:139]
  ds_read_b64_tr_b16 v[184:185], v8 offset:16384
  v_mfma_f32_16x16x32_bf16 v[144:147], v[228:231], v[228:231], v[144:147]
  ds_read_b64_tr_b16 v[186:187], v8 offset:20480
  v_mfma_f32_16x16x32_bf16 v[140:143], v[152:155], v[232:235], v[140:143]
  ds_read_b64_tr_b16 v[188:189], v9 offset:16384
  s_add_u32 m0, s10, 0
  s_nop 0
  buffer_load_dwordx4 v3, s[20:23], s11 offen offset:0 lds
  v_mfma_f32_16x16x32_bf16 v[148:151], v[232:235], v[232:235], v[148:151]
  ds_read_b64_tr_b16 v[190:191], v9 offset:20480
  v_mfma_f32_16x16x32_bf16 v[24:27], v[200:203], v[228:231], v[24:27]
  ds_read_b64_tr_b16 v[192:193], v10 offset:16384
  v_mfma_f32_16x16x32_bf16 v[28:31], v[200:203], v[232:235], v[28:31]
  ds_read_b64_tr_b16 v[194:195], v10 offset:20480
  v_mfma_f32_16x16x32_bf16 v[32:35], v[200:203], v[236:239], v[32:35]
  ds_read_b64_tr_b16 v[196:197], v11 offset:16384
  buffer_load_dwordx4 v3, s[20:23], s11 offen offset:1024 lds
  v_mfma_f32_16x16x32_bf16 v[36:39], v[200:203], v[240:243], v[36:39]
  ds_read_b64_tr_b16 v[198:199], v11 offset:20480
  v_mfma_f32_16x16x32_bf16 v[40:43], v[204:207], v[228:231], v[40:43]
  ds_read_b128 v[156:159], v6 offset:28672
  v_mfma_f32_16x16x32_bf16 v[44:47], v[204:207], v[232:235], v[44:47]
  ds_read_b128 v[160:163], v6 offset:29696
  v_mfma_f32_16x16x32_bf16 v[48:51], v[204:207], v[236:239], v[48:51]
  ds_read_b128 v[164:167], v6 offset:30720
  v_mfma_f32_16x16x32_bf16 v[52:55], v[204:207], v[240:243], v[52:55]
  ds_read_b128 v[168:171], v6 offset:31744
  buffer_load_dwordx4 v3, s[20:23], s11 offen offset:2048 lds
  v_mfma_f32_16x16x32_bf16 v[56:59], v[208:211], v[228:231], v[56:59]
  ds_read_b128 v[172:175], v6 offset:32768
  v_mfma_f32_16x16x32_bf16 v[60:63], v[208:211], v[232:235], v[60:63]
  ds_read_b128 v[176:179], v6 offset:33792
  v_mfma_f32_16x16x32_bf16 v[64:67], v[208:211], v[236:239], v[64:67]
  ds_read_b128 v[180:183], v6 offset:34816
  v_mfma_f32_16x16x32_bf16 v[68:71], v[208:211], v[240:243], v[68:71]
  v_mfma_f32_16x16x32_bf16 v[72:75], v[212:215], v[228:231], v[72:75]
  buffer_load_dwordx4 a[36:39], v4, s[40:43], s54 offen
  s_sub_u32 s54, s54, 148480
  v_mfma_f32_16x16x32_bf16 v[76:79], v[212:215], v[232:235], v[76:79]
  v_mfma_f32_16x16x32_bf16 v[80:83], v[212:215], v[236:239], v[80:83]
  v_mfma_f32_16x16x32_bf16 v[84:87], v[212:215], v[240:243], v[84:87]
  v_mfma_f32_16x16x32_bf16 v[88:91], v[216:219], v[228:231], v[88:91]
  buffer_load_dwordx4 v3, s[20:23], s11 offen offset:3072 lds
  s_add_u32 s11, s11, 16384
  v_mfma_f32_16x16x32_bf16 v[92:95], v[216:219], v[232:235], v[92:95]
  v_mfma_f32_16x16x32_bf16 v[96:99], v[216:219], v[236:239], v[96:99]
  v_mfma_f32_16x16x32_bf16 v[100:103], v[216:219], v[240:243], v[100:103]
  v_mfma_f32_16x16x32_bf16 v[104:107], v[220:223], v[228:231], v[104:107]
  v_mfma_f32_16x16x32_bf16 v[108:111], v[220:223], v[232:235], v[108:111]
  s_add_u32 m0, s8, 0
  s_nop 0
  buffer_load_dwordx4 v3, s[20:23], s9 offen offset:0 lds
  v_mfma_f32_16x16x32_bf16 v[112:115], v[220:223], v[236:239], v[112:115]
  v_mfma_f32_16x16x32_bf16 v[116:119], v[220:223], v[240:243], v[116:119]
  v_mfma_f32_16x16x32_bf16 v[120:123], v[224:227], v[228:231], v[120:123]
  v_mfma_f32_16x16x32_bf16 v[124:127], v[224:227], v[232:235], v[124:127]
  buffer_load_dwordx4 v3, s[20:23], s9 offen offset:1024 lds
  v_mfma_f32_16x16x32_bf16 v[128:131], v[224:227], v[236:239], v[128:131]
  v_mfma_f32_16x16x32_bf16 v[132:135], v[224:227], v[240:243], v[132:135]
  s_waitcnt lgkmcnt(13)
  v_mfma_f32_16x16x32_bf16 v[136:139], v[152:155], v[184:187], v[136:139]
  ds_read_b64_tr_b16 v[228:229], v8 offset:24576
  v_mfma_f32_16x16x32_bf16 v[144:147], v[184:187], v[184:187], v[144:147]
  ds_read_b64_tr_b16 v[230:231], v8 offset:28672
  s_waitcnt lgkmcnt(13)
  v_mfma_f32_16x16x32_bf16 v[140:143], v[152:155], v[188:191], v[140:143]
  ds_read_b64_tr_b16 v[232:233], v9 offset:24576
  buffer_load_dwordx4 v3, s[20:23], s9 offen offset:2048 lds
  v_mfma_f32_16x16x32_bf16 v[148:151], v[188:191], v[188:191], v[148:151]
  ds_read_b64_tr_b16 v[234:235], v9 offset:28672
  s_waitcnt lgkmcnt(10)
  v_mfma_f32_16x16x32_bf16 v[24:27], v[156:159], v[184:187], v[24:27]
  ds_read_b64_tr_b16 v[236:237], v10 offset:24576
  v_mfma_f32_16x16x32_bf16 v[28:31], v[156:159], v[188:191], v[28:31]
  ds_read_b64_tr_b16 v[238:239], v10 offset:28672
  v_mfma_f32_16x16x32_bf16 v[32:35], v[156:159], v[192:195], v[32:35]
  ds_read_b64_tr_b16 v[240:241], v11 offset:24576
  buffer_load_dwordx4 a[40:43], v3, s[40:43], s54 offen
  v_mfma_f32_16x16x32_bf16 v[36:39], v[156:159], v[196:199], v[36:39]
  ds_read_b64_tr_b16 v[242:243], v11 offset:28672
  s_waitcnt lgkmcnt(13)
  v_mfma_f32_16x16x32_bf16 v[40:43], v[160:163], v[184:187], v[40:43]
  ds_read_b128 v[200:203], v6 offset:43008
  v_mfma_f32_16x16x32_bf16 v[44:47], v[160:163], v[188:191], v[44:47]
  ds_read_b128 v[204:207], v6 offset:44032
  v_mfma_f32_16x16x32_bf16 v[48:51], v[160:163], v[192:195], v[48:51]
  ds_read_b128 v[208:211], v6 offset:45056
  v_mfma_f32_16x16x32_bf16 v[52:55], v[160:163], v[196:199], v[52:55]
  ds_read_b128 v[212:215], v6 offset:46080
  buffer_load_dwordx4 v3, s[20:23], s9 offen offset:3072 lds
  s_waitcnt lgkmcnt(15)
  v_mfma_f32_16x16x32_bf16 v[56:59], v[164:167], v[184:187], v[56:59]
  ds_read_b128 v[216:219], v6 offset:47104
  v_mfma_f32_16x16x32_bf16 v[60:63], v[164:167], v[188:191], v[60:63]
  ds_read_b128 v[220:223], v6 offset:48128
  v_mfma_f32_16x16x32_bf16 v[64:67], v[164:167], v[192:195], v[64:67]
  ds_read_b128 v[224:227], v6 offset:49152
  v_mfma_f32_16x16x32_bf16 v[68:71], v[164:167], v[196:199], v[68:71]
  v_mfma_f32_16x16x32_bf16 v[72:75], v[168:171], v[184:187], v[72:75]
  s_add_u32 m0, s8, 4096
  s_nop 0
  buffer_load_dwordx4 v4, s[20:23], s9 offen offset:0 lds
  v_mfma_f32_16x16x32_bf16 v[76:79], v[168:171], v[188:191], v[76:79]
  v_mfma_f32_16x16x32_bf16 v[80:83], v[168:171], v[192:195], v[80:83]
  v_mfma_f32_16x16x32_bf16 v[84:87], v[168:171], v[196:199], v[84:87]
  s_waitcnt lgkmcnt(15)
  v_mfma_f32_16x16x32_bf16 v[88:91], v[172:175], v[184:187], v[88:91]
  buffer_load_dwordx4 v4, s[20:23], s9 offen offset:1024 lds
  v_mfma_f32_16x16x32_bf16 v[92:95], v[172:175], v[188:191], v[92:95]
  v_mfma_f32_16x16x32_bf16 v[96:99], v[172:175], v[192:195], v[96:99]
  v_mfma_f32_16x16x32_bf16 v[100:103], v[172:175], v[196:199], v[100:103]
  v_mfma_f32_16x16x32_bf16 v[104:107], v[176:179], v[184:187], v[104:107]
  v_mfma_f32_16x16x32_bf16 v[108:111], v[176:179], v[188:191], v[108:111]
  buffer_load_dwordx4 a[44:47], v3, s[40:43], s54 offen offset:1024
  v_mfma_f32_16x16x32_bf16 v[112:115], v[176:179], v[192:195], v[112:115]
  v_mfma_f32_16x16x32_bf16 v[116:119], v[176:179], v[196:199], v[116:119]
  v_mfma_f32_16x16x32_bf16 v[120:123], v[180:183], v[184:187], v[120:123]
  v_mfma_f32_16x16x32_bf16 v[124:127], v[180:183], v[188:191], v[124:127]
  buffer_load_dwordx4 v4, s[20:23], s9 offen offset:2048 lds
  s_add_u32 s9, s9, 28672
  v_mfma_f32_16x16x32_bf16 v[128:131], v[180:183], v[192:195], v[128:131]
  v_mfma_f32_16x16x32_bf16 v[132:135], v[180:183], v[196:199], v[132:135]
  s_waitcnt lgkmcnt(0)
  s_waitcnt vmcnt(14)
  s_barrier
  v_mfma_f32_16x16x32_bf16 v[136:139], v[152:155], v[228:231], v[136:139]
  ds_read_b64_tr_b16 v[184:185], v8 offset:32768
  v_mfma_f32_16x16x32_bf16 v[144:147], v[228:231], v[228:231], v[144:147]
  ds_read_b64_tr_b16 v[186:187], v8 offset:36864
  v_mfma_f32_16x16x32_bf16 v[140:143], v[152:155], v[232:235], v[140:143]
  ds_read_b64_tr_b16 v[188:189], v9 offset:32768
  buffer_load_dwordx4 a[48:51], v3, s[40:43], s54 offen offset:2048
  v_mfma_f32_16x16x32_bf16 v[148:151], v[232:235], v[232:235], v[148:151]
  ds_read_b64_tr_b16 v[190:191], v9 offset:36864
  v_mfma_f32_16x16x32_bf16 v[24:27], v[200:203], v[228:231], v[24:27]
  ds_read_b64_tr_b16 v[192:193], v10 offset:32768
  v_mfma_f32_16x16x32_bf16 v[28:31], v[200:203], v[232:235], v[28:31]
  ds_read_b64_tr_b16 v[194:195], v10 offset:36864
  v_mfma_f32_16x16x32_bf16 v[32:35], v[200:203], v[236:239], v[32:35]
  ds_read_b64_tr_b16 v[196:197], v11 offset:32768
  s_add_u32 m0, s57, 0
  s_nop 0
  buffer_load_dwordx4 v248, s[20:23], s55 offen lds
  s_add_u32 s55, s55, 8192
  v_mfma_f32_16x16x32_bf16 v[36:39], v[200:203], v[240:243], v[36:39]
  ds_read_b64_tr_b16 v[198:199], v11 offset:36864
  v_mfma_f32_16x16x32_bf16 v[40:43], v[204:207], v[228:231], v[40:43]
  ds_read_b128 v[156:159], v7 offset:0
  v_mfma_f32_16x16x32_bf16 v[44:47], v[204:207], v[232:235], v[44:47]
  ds_read_b128 v[160:163], v7 offset:1024
  v_mfma_f32_16x16x32_bf16 v[48:51], v[204:207], v[236:239], v[48:51]
  ds_read_b128 v[164:167], v7 offset:2048
  buffer_load_dwordx4 a[52:55], v3, s[40:43], s54 offen offset:3072
  v_mfma_f32_16x16x32_bf16 v[52:55], v[204:207], v[240:243], v[52:55]
  ds_read_b128 v[168:171], v7 offset:3072
  v_mfma_f32_16x16x32_bf16 v[56:59], v[208:211], v[228:231], v[56:59]
  ds_read_b128 v[172:175], v7 offset:4096
  v_mfma_f32_16x16x32_bf16 v[60:63], v[208:211], v[232:235], v[60:63]
  ds_read_b128 v[176:179], v7 offset:5120
  v_mfma_f32_16x16x32_bf16 v[64:67], v[208:211], v[236:239], v[64:67]
  ds_read_b128 v[180:183], v7 offset:6144
  s_add_u32 m0, s57, 1024
  s_nop 0
  buffer_load_dwordx4 v248, s[20:23], s55 offen lds
  s_add_u32 s55, s55, 8192
  v_mfma_f32_16x16x32_bf16 v[68:71], v[208:211], v[240:243], v[68:71]
  v_mfma_f32_16x16x32_bf16 v[72:75], v[212:215], v[228:231], v[72:75]
  v_mfma_f32_16x16x32_bf16 v[76:79], v[212:215], v[232:235], v[76:79]
  v_mfma_f32_16x16x32_bf16 v[80:83], v[212:215], v[236:239], v[80:83]
  buffer_load_dwordx4 a[56:59], v4, s[40:43], s54 offen
  s_add_u32 s54, s54, 20480
  v_mfma_f32_16x16x32_bf16 v[84:87], v[212:215], v[240:243], v[84:87]
  v_mfma_f32_16x16x32_bf16 v[88:91], v[216:219], v[228:231], v[88:91]
  v_mfma_f32_16x16x32_bf16 v[92:95], v[216:219], v[232:235], v[92:95]
  v_mfma_f32_16x16x32_bf16 v[96:99], v[216:219], v[236:239], v[96:99]
  buffer_load_dwordx4 a[60:63], v3, s[40:43], s54 offen
  v_mfma_f32_16x16x32_bf16 v[100:103], v[216:219], v[240:243], v[100:103]
  v_mfma_f32_16x16x32_bf16 v[104:107], v[220:223], v[228:231], v[104:107]
  v_mfma_f32_16x16x32_bf16 v[108:111], v[220:223], v[232:235], v[108:111]
  v_mfma_f32_16x16x32_bf16 v[112:115], v[220:223], v[236:239], v[112:115]
  s_add_u32 m0, s57, 2048
  s_mov_b32 exec_hi, 0
  buffer_load_dwordx4 v248, s[20:23], s55 offen lds
  s_mov_b32 exec_hi, -1
  v_mfma_f32_16x16x32_bf16 v[116:119], v[220:223], v[240:243], v[116:119]
  v_mfma_f32_16x16x32_bf16 v[120:123], v[224:227], v[228:231], v[120:123]
  v_mfma_f32_16x16x32_bf16 v[124:127], v[224:227], v[232:235], v[124:127]
  v_mfma_f32_16x16x32_bf16 v[128:131], v[224:227], v[236:239], v[128:131]
  buffer_load_dwordx4 a[64:67], v3, s[40:43], s54 offen offset:1024
  v_mfma_f32_16x16x32_bf16 v[132:135], v[224:227], v[240:243], v[132:135]
  s_waitcnt lgkmcnt(13)
  v_mfma_f32_16x16x32_bf16 v[136:139], v[152:155], v[184:187], v[136:139]
  ds_read_b64_tr_b16 v[228:229], v8 offset:40960
  v_mfma_f32_16x16x32_bf16 v[144:147], v[184:187], v[184:187], v[144:147]
  ds_read_b64_tr_b16 v[230:231], v8 offset:45056
  s_waitcnt lgkmcnt(13)
  v_mfma_f32_16x16x32_bf16 v[140:143], v[152:155], v[188:191], v[140:143]
  ds_read_b64_tr_b16 v[232:233], v9 offset:40960
  buffer_load_dwordx4 a[68:71], v3, s[40:43], s54 offen offset:2048
  v_mfma_f32_16x16x32_bf16 v[148:151], v[188:191], v[188:191], v[148:151]
  ds_read_b64_tr_b16 v[234:235], v9 offset:45056
  s_waitcnt lgkmcnt(10)
  v_mfma_f32_16x16x32_bf16 v[24:27], v[156:159], v[184:187], v[24:27]
  ds_read_b64_tr_b16 v[236:237], v10 offset:40960
  v_mfma_f32_16x16x32_bf16 v[28:31], v[156:159], v[188:191], v[28:31]
  ds_read_b64_tr_b16 v[238:239], v10 offset:45056
  v_mfma_f32_16x16x32_bf16 v[32:35], v[156:159], v[192:195], v[32:35]
  ds_read_b64_tr_b16 v[240:241], v11 offset:40960
  buffer_load_dwordx4 a[72:75], v3, s[40:43], s54 offen offset:3072
  v_mfma_f32_16x16x32_bf16 v[36:39], v[156:159], v[196:199], v[36:39]
  ds_read_b64_tr_b16 v[242:243], v11 offset:45056
  s_waitcnt lgkmcnt(13)
  v_mfma_f32_16x16x32_bf16 v[40:43], v[160:163], v[184:187], v[40:43]
  ds_read_b128 v[200:203], v7 offset:14336
  v_mfma_f32_16x16x32_bf16 v[44:47], v[160:163], v[188:191], v[44:47]
  ds_read_b128 v[204:207], v7 offset:15360
  v_mfma_f32_16x16x32_bf16 v[48:51], v[160:163], v[192:195], v[48:51]
  ds_read_b128 v[208:211], v7 offset:16384
  buffer_load_dwordx4 a[76:79], v4, s[40:43], s54 offen
  s_add_u32 s54, s54, 122880
  v_mfma_f32_16x16x32_bf16 v[52:55], v[160:163], v[196:199], v[52:55]
  ds_read_b128 v[212:215], v7 offset:17408
  s_waitcnt lgkmcnt(15)
  v_mfma_f32_16x16x32_bf16 v[56:59], v[164:167], v[184:187], v[56:59]
  ds_read_b128 v[216:219], v7 offset:18432
  v_mfma_f32_16x16x32_bf16 v[60:63], v[164:167], v[188:191], v[60:63]
  ds_read_b128 v[220:223], v7 offset:19456
  v_mfma_f32_16x16x32_bf16 v[64:67], v[164:167], v[192:195], v[64:67]
  ds_read_b128 v[224:227], v7 offset:20480
  buffer_load_dwordx4 a[80:83], v3, s[40:43], s54 offen
  v_mfma_f32_16x16x32_bf16 v[68:71], v[164:167], v[196:199], v[68:71]
  v_mfma_f32_16x16x32_bf16 v[72:75], v[168:171], v[184:187], v[72:75]
  v_mfma_f32_16x16x32_bf16 v[76:79], v[168:171], v[188:191], v[76:79]
  v_mfma_f32_16x16x32_bf16 v[80:83], v[168:171], v[192:195], v[80:83]
  buffer_load_dwordx4 a[84:87], v3, s[40:43], s54 offen offset:1024
  v_mfma_f32_16x16x32_bf16 v[84:87], v[168:171], v[196:199], v[84:87]
  s_waitcnt lgkmcnt(15)
  v_mfma_f32_16x16x32_bf16 v[88:91], v[172:175], v[184:187], v[88:91]
  v_mfma_f32_16x16x32_bf16 v[92:95], v[172:175], v[188:191], v[92:95]
  v_mfma_f32_16x16x32_bf16 v[96:99], v[172:175], v[192:195], v[96:99]
  buffer_load_dwordx4 a[88:91], v3, s[40:43], s54 offen offset:2048
  v_mfma_f32_16x16x32_bf16 v[100:103], v[172:175], v[196:199], v[100:103]
  v_mfma_f32_16x16x32_bf16 v[104:107], v[176:179], v[184:187], v[104:107]
  v_mfma_f32_16x16x32_bf16 v[108:111], v[176:179], v[188:191], v[108:111]
  v_mfma_f32_16x16x32_bf16 v[112:115], v[176:179], v[192:195], v[112:115]
  buffer_load_dwordx4 a[92:95], v3, s[40:43], s54 offen offset:3072
  v_mfma_f32_16x16x32_bf16 v[116:119], v[176:179], v[196:199], v[116:119]
  v_mfma_f32_16x16x32_bf16 v[120:123], v[180:183], v[184:187], v[120:123]
  v_mfma_f32_16x16x32_bf16 v[124:127], v[180:183], v[188:191], v[124:127]
  v_mfma_f32_16x16x32_bf16 v[128:131], v[180:183], v[192:195], v[128:131]
  buffer_load_dwordx4 a[96:99], v4, s[40:43], s54 offen
  s_add_u32 s54, s54, 20480
  v_mfma_f32_16x16x32_bf16 v[132:135], v[180:183], v[196:199], v[132:135]
  s_waitcnt lgkmcnt(0)
  s_waitcnt vmcnt(16)
  s_barrier
  v_mfma_f32_16x16x32_bf16 v[136:139], v[152:155], v[228:231], v[136:139]
  ds_read_b64_tr_b16 v[184:185], v8 offset:0
  v_mfma_f32_16x16x32_bf16 v[144:147], v[228:231], v[228:231], v[144:147]
  ds_read_b64_tr_b16 v[186:187], v8 offset:4096
  v_mfma_f32_16x16x32_bf16 v[140:143], v[152:155], v[232:235], v[140:143]
  ds_read_b64_tr_b16 v[188:189], v9 offset:0
  buffer_load_dwordx4 a[100:103], v3, s[40:43], s54 offen
  v_mfma_f32_16x16x32_bf16 v[148:151], v[232:235], v[232:235], v[148:151]
  ds_read_b64_tr_b16 v[190:191], v9 offset:4096
  v_mfma_f32_16x16x32_bf16 v[24:27], v[200:203], v[228:231], v[24:27]
  ds_read_b64_tr_b16 v[192:193], v10 offset:0
  v_mfma_f32_16x16x32_bf16 v[28:31], v[200:203], v[232:235], v[28:31]
  ds_read_b64_tr_b16 v[194:195], v10 offset:4096
  v_mfma_f32_16x16x32_bf16 v[32:35], v[200:203], v[236:239], v[32:35]
  ds_read_b64_tr_b16 v[196:197], v11 offset:0
  buffer_load_dwordx4 a[104:107], v3, s[40:43], s54 offen offset:1024
  v_mfma_f32_16x16x32_bf16 v[36:39], v[200:203], v[240:243], v[36:39]
  ds_read_b64_tr_b16 v[198:199], v11 offset:4096
  v_mfma_f32_16x16x32_bf16 v[40:43], v[204:207], v[228:231], v[40:43]
  ds_read_b128 v[156:159], v6 offset:0
  v_mfma_f32_16x16x32_bf16 v[44:47], v[204:207], v[232:235], v[44:47]
  ds_read_b128 v[160:163], v6 offset:1024
  v_mfma_f32_16x16x32_bf16 v[48:51], v[204:207], v[236:239], v[48:51]
  ds_read_b128 v[164:167], v6 offset:2048
  buffer_load_dwordx4 a[108:111], v3, s[40:43], s54 offen offset:2048
  v_mfma_f32_16x16x32_bf16 v[52:55], v[204:207], v[240:243], v[52:55]
  ds_read_b128 v[168:171], v6 offset:3072
  v_mfma_f32_16x16x32_bf16 v[56:59], v[208:211], v[228:231], v[56:59]
  ds_read_b128 v[172:175], v6 offset:4096
  v_mfma_f32_16x16x32_bf16 v[60:63], v[208:211], v[232:235], v[60:63]
  ds_read_b128 v[176:179], v6 offset:5120
  v_mfma_f32_16x16x32_bf16 v[64:67], v[208:211], v[236:239], v[64:67]
  ds_read_b128 v[180:183], v6 offset:6144
  buffer_load_dwordx4 a[112:115], v3, s[40:43], s54 offen offset:3072
  v_mfma_f32_16x16x32_bf16 v[68:71], v[208:211], v[240:243], v[68:71]
  v_mfma_f32_16x16x32_bf16 v[72:75], v[212:215], v[228:231], v[72:75]
  v_mfma_f32_16x16x32_bf16 v[76:79], v[212:215], v[232:235], v[76:79]
  v_mfma_f32_16x16x32_bf16 v[80:83], v[212:215], v[236:239], v[80:83]
  buffer_load_dwordx4 a[116:119], v4, s[40:43], s54 offen
  s_sub_u32 s54, s54, 174080
  v_mfma_f32_16x16x32_bf16 v[84:87], v[212:215], v[240:243], v[84:87]
  v_mfma_f32_16x16x32_bf16 v[88:91], v[216:219], v[228:231], v[88:91]
  v_mfma_f32_16x16x32_bf16 v[92:95], v[216:219], v[232:235], v[92:95]
  v_mfma_f32_16x16x32_bf16 v[96:99], v[216:219], v[236:239], v[96:99]
  buffer_load_dwordx4 a[120:123], v3, s[40:43], s54 offen
  v_mfma_f32_16x16x32_bf16 v[100:103], v[216:219], v[240:243], v[100:103]
  v_mfma_f32_16x16x32_bf16 v[104:107], v[220:223], v[228:231], v[104:107]
  v_mfma_f32_16x16x32_bf16 v[108:111], v[220:223], v[232:235], v[108:111]
  v_mfma_f32_16x16x32_bf16 v[112:115], v[220:223], v[236:239], v[112:115]
  buffer_load_dwordx4 a[124:127], v3, s[40:43], s54 offen offset:1024
  v_mfma_f32_16x16x32_bf16 v[116:119], v[220:223], v[240:243], v[116:119]
  v_mfma_f32_16x16x32_bf16 v[120:123], v[224:227], v[228:231], v[120:123]
  v_mfma_f32_16x16x32_bf16 v[124:127], v[224:227], v[232:235], v[124:127]
  v_mfma_f32_16x16x32_bf16 v[128:131], v[224:227], v[236:239], v[128:131]
  buffer_load_dwordx4 a[128:131], v3, s[40:43], s54 offen offset:2048
  v_mfma_f32_16x16x32_bf16 v[132:135], v[224:227], v[240:243], v[132:135]
  s_waitcnt lgkmcnt(13)
  v_mfma_f32_16x16x32_bf16 v[136:139], v[152:155], v[184:187], v[136:139]
  ds_read_b64_tr_b16 v[228:229], v8 offset:8192
  v_mfma_f32_16x16x32_bf16 v[144:147], v[184:187], v[184:187], v[144:147]
  ds_read_b64_tr_b16 v[230:231], v8 offset:12288
  buffer_load_dword v21, v22, s[20:23], s37 offen sc1
  s_waitcnt lgkmcnt(13)
  v_mfma_f32_16x16x32_bf16 v[140:143], v[152:155], v[188:191], v[140:143]
  ds_read_b64_tr_b16 v[232:233], v9 offset:8192
  v_mfma_f32_16x16x32_bf16 v[148:151], v[188:191], v[188:191], v[148:151]
  ds_read_b64_tr_b16 v[234:235], v9 offset:12288
  s_waitcnt lgkmcnt(10)
  v_mfma_f32_16x16x32_bf16 v[24:27], v[156:159], v[184:187], v[24:27]
  ds_read_b64_tr_b16 v[236:237], v10 offset:8192
  v_mfma_f32_16x16x32_bf16 v[28:31], v[156:159], v[188:191], v[28:31]
  ds_read_b64_tr_b16 v[238:239], v10 offset:12288
  buffer_load_dwordx4 a[132:135], v3, s[40:43], s54 offen offset:3072
  v_mfma_f32_16x16x32_bf16 v[32:35], v[156:159], v[192:195], v[32:35]
  ds_read_b64_tr_b16 v[240:241], v11 offset:8192
  v_mfma_f32_16x16x32_bf16 v[36:39], v[156:159], v[196:199], v[36:39]
  ds_read_b64_tr_b16 v[242:243], v11 offset:12288
  s_waitcnt lgkmcnt(13)
  v_mfma_f32_16x16x32_bf16 v[40:43], v[160:163], v[184:187], v[40:43]
  ds_read_b128 v[200:203], v6 offset:14336
  buffer_load_dwordx4 a[136:139], v4, s[40:43], s54 offen
  s_add_u32 s54, s54, 20480
  v_mfma_f32_16x16x32_bf16 v[44:47], v[160:163], v[188:191], v[44:47]
  ds_read_b128 v[204:207], v6 offset:15360
  v_mfma_f32_16x16x32_bf16 v[48:51], v[160:163], v[192:195], v[48:51]
  ds_read_b128 v[208:211], v6 offset:16384
  v_mfma_f32_16x16x32_bf16 v[52:55], v[160:163], v[196:199], v[52:55]
  ds_read_b128 v[212:215], v6 offset:17408
  s_waitcnt lgkmcnt(15)
  v_mfma_f32_16x16x32_bf16 v[56:59], v[164:167], v[184:187], v[56:59]
  ds_read_b128 v[216:219], v6 offset:18432
  buffer_load_dwordx4 a[140:143], v3, s[40:43], s54 offen
  v_mfma_f32_16x16x32_bf16 v[60:63], v[164:167], v[188:191], v[60:63]
  ds_read_b128 v[220:223], v6 offset:19456
  v_mfma_f32_16x16x32_bf16 v[64:67], v[164:167], v[192:195], v[64:67]
  ds_read_b128 v[224:227], v6 offset:20480
  v_mfma_f32_16x16x32_bf16 v[68:71], v[164:167], v[196:199], v[68:71]
  v_mfma_f32_16x16x32_bf16 v[72:75], v[168:171], v[184:187], v[72:75]
  buffer_load_dwordx4 a[144:147], v3, s[40:43], s54 offen offset:1024
  v_mfma_f32_16x16x32_bf16 v[76:79], v[168:171], v[188:191], v[76:79]
  v_mfma_f32_16x16x32_bf16 v[80:83], v[168:171], v[192:195], v[80:83]
  v_mfma_f32_16x16x32_bf16 v[84:87], v[168:171], v[196:199], v[84:87]
  buffer_load_dwordx4 a[148:151], v3, s[40:43], s54 offen offset:2048
  s_waitcnt lgkmcnt(15)
  v_mfma_f32_16x16x32_bf16 v[88:91], v[172:175], v[184:187], v[88:91]
  v_mfma_f32_16x16x32_bf16 v[92:95], v[172:175], v[188:191], v[92:95]
  v_mfma_f32_16x16x32_bf16 v[96:99], v[172:175], v[192:195], v[96:99]
  v_mfma_f32_16x16x32_bf16 v[100:103], v[172:175], v[196:199], v[100:103]
  buffer_load_dwordx4 a[152:155], v3, s[40:43], s54 offen offset:3072
  v_mfma_f32_16x16x32_bf16 v[104:107], v[176:179], v[184:187], v[104:107]
  v_mfma_f32_16x16x32_bf16 v[108:111], v[176:179], v[188:191], v[108:111]
  v_mfma_f32_16x16x32_bf16 v[112:115], v[176:179], v[192:195], v[112:115]
  buffer_load_dwordx4 a[156:159], v4, s[40:43], s54 offen
  s_sub_u32 s54, s54, 15360
  v_mfma_f32_16x16x32_bf16 v[116:119], v[176:179], v[196:199], v[116:119]
  v_mfma_f32_16x16x32_bf16 v[120:123], v[180:183], v[184:187], v[120:123]
  v_mfma_f32_16x16x32_bf16 v[124:127], v[180:183], v[188:191], v[124:127]
  v_mfma_f32_16x16x32_bf16 v[128:131], v[180:183], v[192:195], v[128:131]
  buffer_load_dwordx4 a[160:163], v3, s[40:43], s54 offen
  v_mfma_f32_16x16x32_bf16 v[132:135], v[180:183], v[196:199], v[132:135]
  s_waitcnt lgkmcnt(13)
  v_mfma_f32_16x16x32_bf16 v[136:139], v[152:155], v[228:231], v[136:139]
  ds_read_b128 v[156:159], v15 offset:0
  v_mfma_f32_16x16x32_bf16 v[144:147], v[228:231], v[228:231], v[144:147]
  ds_read_b128 v[160:163], v15 offset:64
  s_waitcnt lgkmcnt(13)
  v_mfma_f32_16x16x32_bf16 v[140:143], v[152:155], v[232:235], v[140:143]
  ds_read_b128 v[164:167], v15 offset:128
  buffer_load_dwordx4 a[164:167], v3, s[40:43], s54 offen offset:1024
  v_mfma_f32_16x16x32_bf16 v[148:151], v[232:235], v[232:235], v[148:151]
  ds_read_b128 v[168:171], v15 offset:192
  s_waitcnt lgkmcnt(4)
  v_mfma_f32_16x16x32_bf16 v[120:123], v[224:227], v[228:231], v[120:123]
  ds_read_b128 v[172:175], v15 offset:256
  v_mfma_f32_16x16x32_bf16 v[124:127], v[224:227], v[232:235], v[124:127]
  ds_read_b128 v[176:179], v15 offset:320
  v_mfma_f32_16x16x32_bf16 v[128:131], v[224:227], v[236:239], v[128:131]
  ds_read_b128 v[180:183], v15 offset:384
  v_cndmask_b32 v137, v144, v145, s[24:25]
  v_cndmask_b32 v141, v148, v149, s[24:25]
  buffer_load_dwordx4 a[168:171], v3, s[40:43], s54 offen offset:2048
  v_mfma_f32_16x16x32_bf16 v[132:135], v[224:227], v[240:243], v[132:135]
  v_cndmask_b32 v137, v137, v146, s[26:27]
  v_cndmask_b32 v141, v141, v150, s[26:27]
  v_mfma_f32_16x16x32_bf16 v[56:59], v[208:211], v[228:231], v[56:59]
  v_cndmask_b32 v137, v137, v147, s[28:29]
  v_cndmask_b32 v141, v141, v151, s[28:29]
  v_mfma_f32_16x16x32_bf16 v[60:63], v[208:211], v[232:235], v[60:63]
  s_mov_b32 exec_lo, 0x00f0000f
  s_mov_b32 exec_hi, 0xf0000f00
  ds_write_b64 v13, v[136:137] offset:0
  ds_write_b64 v13, v[140:141] offset:128
  s_mov_b64 exec, -1
  v_mfma_f32_16x16x32_bf16 v[64:67], v[208:211], v[236:239], v[64:67]
  buffer_load_dwordx4 a[172:175], v3, s[40:43], s54 offen offset:3072
  v_mfma_f32_16x16x32_bf16 v[68:71], v[208:211], v[240:243], v[68:71]
  v_mfma_f32_16x16x32_bf16 v[104:107], v[220:223], v[228:231], v[104:107]
  v_mfma_f32_16x16x32_bf16 v[108:111], v[220:223], v[232:235], v[108:111]
  s_waitcnt lgkmcnt(0)
  s_barrier
  ds_read_b64 v[184:185], v13 offset:0
  ds_read_b64 v[188:189], v13 offset:128
  ds_read_b64 v[192:193], v14 offset:0
  ds_read_b64 v[196:197], v14 offset:128
  v_mfma_f32_16x16x32_bf16 v[112:115], v[220:223], v[236:239], v[112:115]
  buffer_load_dwordx4 a[176:179], v4, s[40:43], s54 offen
  s_add_u32 s54, s54, 20480
  v_mfma_f32_16x16x32_bf16 v[116:119], v[220:223], v[240:243], v[116:119]
  v_mfma_f32_16x16x32_bf16 v[24:27], v[200:203], v[228:231], v[24:27]
  v_mfma_f32_16x16x32_bf16 v[28:31], v[200:203], v[232:235], v[28:31]
  v_mfma_f32_16x16x32_bf16 v[32:35], v[200:203], v[236:239], v[32:35]
  buffer_load_dwordx4 a[180:183], v3, s[40:43], s54 offen
  v_mfma_f32_16x16x32_bf16 v[36:39], v[200:203], v[240:243], v[36:39]
  s_waitcnt lgkmcnt(3)
  v_mul_f32 v184, 0xbacccccd, v184
  s_waitcnt lgkmcnt(2)
  v_mul_f32 v188, 0xbacccccd, v188
  v_mfma_f32_16x16x32_bf16 v[72:75], v[212:215], v[228:231], v[72:75]
  s_waitcnt lgkmcnt(1)
  v_mul_f32 v192, 0xbacccccd, v192
  s_waitcnt lgkmcnt(0)
  v_mul_f32 v196, 0xbacccccd, v196
  v_mfma_f32_16x16x32_bf16 v[76:79], v[212:215], v[232:235], v[76:79]
  v_mul_f32 v185, 0x3acccccd, v185
  v_mul_f32 v189, 0x3acccccd, v189
  v_mfma_f32_16x16x32_bf16 v[80:83], v[212:215], v[236:239], v[80:83]
  v_mul_f32 v193, 0x3acccccd, v193
  v_mul_f32 v197, 0x3acccccd, v197
  buffer_load_dwordx4 a[184:187], v3, s[40:43], s54 offen offset:1024
  v_mfma_f32_16x16x32_bf16 v[84:87], v[212:215], v[240:243], v[84:87]
  v_fma_f32 v185, -v184, v184, v185
  v_fma_f32 v189, -v188, v188, v189
  v_mfma_f32_16x16x32_bf16 v[40:43], v[204:207], v[228:231], v[40:43]
  v_fma_f32 v193, -v192, v192, v193
  v_fma_f32 v197, -v196, v196, v197
  v_mfma_f32_16x16x32_bf16 v[44:47], v[204:207], v[232:235], v[44:47]
  v_max_f32 v185, 0, v185
  v_max_f32 v189, 0, v189
  v_mfma_f32_16x16x32_bf16 v[48:51], v[204:207], v[236:239], v[48:51]
  v_max_f32 v193, 0, v193
  v_max_f32 v197, 0, v197
  buffer_load_dwordx4 a[188:191], v3, s[40:43], s54 offen offset:2048
  v_mfma_f32_16x16x32_bf16 v[52:55], v[204:207], v[240:243], v[52:55]
  v_add_f32 v186, 0x3727c5ac, v185
  v_add_f32 v190, 0x3727c5ac, v189
  v_mfma_f32_16x16x32_bf16 v[88:91], v[216:219], v[228:231], v[88:91]
  v_add_f32 v194, 0x3727c5ac, v193
  v_add_f32 v198, 0x3727c5ac, v197
  v_mfma_f32_16x16x32_bf16 v[92:95], v[216:219], v[232:235], v[92:95]
  v_rsq_f32 v185, v186
  v_rsq_f32 v189, v190
  v_mfma_f32_16x16x32_bf16 v[96:99], v[216:219], v[236:239], v[96:99]
  v_rsq_f32 v193, v194
  v_rsq_f32 v197, v198
  buffer_load_dwordx4 a[192:195], v3, s[40:43], s54 offen offset:3072
  v_mfma_f32_16x16x32_bf16 v[100:103], v[216:219], v[240:243], v[100:103]
  v_mul_f32 v185, 0xbfb8aa3b, v185
  v_mul_f32 v189, 0xbfb8aa3b, v189
  v_mul_f32 v193, 0xbfb8aa3b, v193
  v_mul_f32 v197, 0xbfb8aa3b, v197
  s_waitcnt vmcnt(16)
  v_cmp_ne_u32 vcc, 0, v21
  s_mov_b32 s24, 0
  s_mov_b32 s25, -1
  s_cmp_eq_u64 vcc, -1
  s_cbranch_scc0 L2_fs
L2_fb:
  v_cndmask_b32 v201, v185, v189, s[24:25]
  buffer_load_dwordx4 a[196:199], v4, s[40:43], s54 offen
  s_add_u32 s54, s54, 117760
  v_cndmask_b32 v202, v186, v190, s[24:25]
  v_cndmask_b32 v205, v193, v197, s[24:25]
  v_cndmask_b32 v206, v194, v198, s[24:25]
  v_pk_fma_f32 v[120:121], v[180:181], v[184:185], v[120:121] op_sel_hi:[1,0,1]
  v_pk_fma_f32 v[122:123], v[182:183], v[184:185], v[122:123] op_sel_hi:[1,0,1]
  v_pk_fma_f32 v[124:125], v[180:181], v[188:189], v[124:125] op_sel_hi:[1,0,1]
  v_pk_fma_f32 v[126:127], v[182:183], v[188:189], v[126:127] op_sel_hi:[1,0,1]
  v_pk_fma_f32 v[128:129], v[180:181], v[192:193], v[128:129] op_sel_hi:[1,0,1]
  v_pk_fma_f32 v[130:131], v[182:183], v[192:193], v[130:131] op_sel_hi:[1,0,1]
  v_pk_fma_f32 v[132:133], v[180:181], v[196:197], v[132:133] op_sel_hi:[1,0,1]
  v_pk_fma_f32 v[134:135], v[182:183], v[196:197], v[134:135] op_sel_hi:[1,0,1]
  v_permlane32_swap_b32 v120, v124
  v_permlane32_swap_b32 v121, v125
  v_permlane32_swap_b32 v122, v126
  v_permlane32_swap_b32 v123, v127
  v_permlane32_swap_b32 v128, v132
  buffer_load_dwordx4 a[200:203], v3, s[40:43], s54 offen
  v_permlane32_swap_b32 v129, v133
  v_permlane32_swap_b32 v130, v134
  v_permlane32_swap_b32 v131, v135
  v_pk_mul_f32 v[208:209], v[120:121], v[200:201] op_sel:[0,1] op_sel_hi:[1,1]
  v_pk_mul_f32 v[210:211], v[122:123], v[200:201] op_sel:[0,1] op_sel_hi:[1,1]
  v_pk_mul_f32 v[212:213], v[128:129], v[204:205] op_sel:[0,1] op_sel_hi:[1,1]
  v_pk_mul_f32 v[214:215], v[130:131], v[204:205] op_sel:[0,1] op_sel_hi:[1,1]
  v_exp_f32 v208, v208
  v_exp_f32 v209, v209
  v_exp_f32 v210, v210
  v_exp_f32 v211, v211
  v_pk_mul_f32 v[120:121], v[120:121], v[124:125]
  v_pk_mul_f32 v[122:123], v[122:123], v[126:127]
  v_exp_f32 v212, v212
  buffer_load_dwordx4 a[204:207], v3, s[40:43], s54 offen offset:1024
  v_exp_f32 v213, v213
  v_exp_f32 v214, v214
  v_exp_f32 v215, v215
  v_pk_mul_f32 v[128:129], v[128:129], v[132:133]
  v_pk_mul_f32 v[130:131], v[130:131], v[134:135]
  v_pk_fma_f32 v[208:209], v[208:209], v[202:203], v[202:203] op_sel_hi:[1,0,0]
  v_pk_fma_f32 v[210:211], v[210:211], v[202:203], v[202:203] op_sel_hi:[1,0,0]
  v_pk_fma_f32 v[212:213], v[212:213], v[206:207], v[206:207] op_sel_hi:[1,0,0]
  v_pk_fma_f32 v[214:215], v[214:215], v[206:207], v[206:207] op_sel_hi:[1,0,0]
  v_rcp_f32 v208, v208
  v_rcp_f32 v209, v209
  v_rcp_f32 v210, v210
  buffer_load_dwordx4 a[208:211], v3, s[40:43], s54 offen offset:2048
  v_rcp_f32 v211, v211
  v_rcp_f32 v212, v212
  v_rcp_f32 v213, v213
  v_rcp_f32 v214, v214
  v_rcp_f32 v215, v215
  v_pk_mul_f32 v[120:121], v[120:121], v[208:209]
  v_pk_mul_f32 v[122:123], v[122:123], v[210:211]
  v_pk_mul_f32 v[128:129], v[128:129], v[212:213]
  v_pk_mul_f32 v[130:131], v[130:131], v[214:215]
  v_cvt_pk_bf16_f32 v252, v120, v121
  v_cvt_pk_bf16_f32 v253, v122, v123
  v_cvt_pk_bf16_f32 v254, v128, v129
  v_cvt_pk_bf16_f32 v255, v130, v131
  s_nop 0
  v_permlane16_swap_b32 v252, v254
  v_permlane16_swap_b32 v253, v255
  buffer_load_dwordx4 a[212:215], v3, s[40:43], s54 offen offset:3072
  buffer_store_dwordx4 v[252:255], v23, s[20:23], s34 offen sc1
  v_pk_fma_f32 v[56:57], v[164:165], v[184:185], v[56:57] op_sel_hi:[1,0,1]
  v_pk_fma_f32 v[58:59], v[166:167], v[184:185], v[58:59] op_sel_hi:[1,0,1]
  v_pk_fma_f32 v[104:105], v[176:177], v[184:185], v[104:105] op_sel_hi:[1,0,1]
  v_pk_fma_f32 v[106:107], v[178:179], v[184:185], v[106:107] op_sel_hi:[1,0,1]
  v_pk_fma_f32 v[60:61], v[164:165], v[188:189], v[60:61] op_sel_hi:[1,0,1]
  v_pk_fma_f32 v[62:63], v[166:167], v[188:189], v[62:63] op_sel_hi:[1,0,1]
  v_pk_fma_f32 v[108:109], v[176:177], v[188:189], v[108:109] op_sel_hi:[1,0,1]
  v_pk_fma_f32 v[110:111], v[178:179], v[188:189], v[110:111] op_sel_hi:[1,0,1]
  v_pk_mul_f32 v[208:209], v[56:57], v[184:185] op_sel:[0,1] op_sel_hi:[1,1]
  v_pk_mul_f32 v[210:211], v[58:59], v[184:185] op_sel:[0,1] op_sel_hi:[1,1]
  v_pk_mul_f32 v[212:213], v[60:61], v[188:189] op_sel:[0,1] op_sel_hi:[1,1]
  v_pk_mul_f32 v[214:215], v[62:63], v[188:189] op_sel:[0,1] op_sel_hi:[1,1]
  buffer_load_dwordx4 a[216:219], v4, s[40:43], s54 offen
  s_add_u32 s54, s54, 20480
  v_exp_f32 v208, v208
  v_exp_f32 v209, v209
  v_exp_f32 v210, v210
  v_exp_f32 v211, v211
  v_pk_mul_f32 v[56:57], v[56:57], v[104:105]
  v_pk_mul_f32 v[58:59], v[58:59], v[106:107]
  v_exp_f32 v212, v212
  v_exp_f32 v213, v213
  v_exp_f32 v214, v214
  v_exp_f32 v215, v215
  v_pk_mul_f32 v[60:61], v[60:61], v[108:109]
  v_pk_mul_f32 v[62:63], v[62:63], v[110:111]
  buffer_load_dwordx4 a[220:223], v3, s[40:43], s54 offen
  v_pk_fma_f32 v[208:209], v[208:209], v[186:187], v[186:187] op_sel_hi:[1,0,0]
  v_pk_fma_f32 v[210:211], v[210:211], v[186:187], v[186:187] op_sel_hi:[1,0,0]
  v_pk_fma_f32 v[212:213], v[212:213], v[190:191], v[190:191] op_sel_hi:[1,0,0]
  v_pk_fma_f32 v[214:215], v[214:215], v[190:191], v[190:191] op_sel_hi:[1,0,0]
  v_rcp_f32 v208, v208
  v_rcp_f32 v209, v209
  v_rcp_f32 v210, v210
  v_rcp_f32 v211, v211
  v_rcp_f32 v212, v212
  v_rcp_f32 v213, v213
  v_rcp_f32 v214, v214
  v_rcp_f32 v215, v215
  buffer_load_dwordx4 a[224:227], v3, s[40:43], s54 offen offset:1024
  v_pk_mul_f32 v[56:57], v[56:57], v[208:209]
  v_pk_mul_f32 v[58:59], v[58:59], v[210:211]
  v_pk_mul_f32 v[60:61], v[60:61], v[212:213]
  v_pk_mul_f32 v[62:63], v[62:63], v[214:215]
  v_cvt_pk_bf16_f32 v244, v56, v57
  v_cvt_pk_bf16_f32 v245, v58, v59
  v_cvt_pk_bf16_f32 v246, v60, v61
  v_cvt_pk_bf16_f32 v247, v62, v63
  s_nop 0
  v_permlane32_swap_b32 v244, v246
  v_permlane32_swap_b32 v245, v247
  buffer_store_dwordx4 v[244:247], v20, s[20:23], s32 offen sc1
  v_pk_fma_f32 v[64:65], v[164:165], v[192:193], v[64:65] op_sel_hi:[1,0,1]
  v_pk_fma_f32 v[66:67], v[166:167], v[192:193], v[66:67] op_sel_hi:[1,0,1]
  v_pk_fma_f32 v[112:113], v[176:177], v[192:193], v[112:113] op_sel_hi:[1,0,1]
  v_pk_fma_f32 v[114:115], v[178:179], v[192:193], v[114:115] op_sel_hi:[1,0,1]
  v_pk_fma_f32 v[68:69], v[164:165], v[196:197], v[68:69] op_sel_hi:[1,0,1]
  v_pk_fma_f32 v[70:71], v[166:167], v[196:197], v[70:71] op_sel_hi:[1,0,1]
  v_pk_fma_f32 v[116:117], v[176:177], v[196:197], v[116:117] op_sel_hi:[1,0,1]
  v_pk_fma_f32 v[118:119], v[178:179], v[196:197], v[118:119] op_sel_hi:[1,0,1]
  v_pk_mul_f32 v[208:209], v[64:65], v[192:193] op_sel:[0,1] op_sel_hi:[1,1]
  v_pk_mul_f32 v[210:211], v[66:67], v[192:193] op_sel:[0,1] op_sel_hi:[1,1]
  v_pk_mul_f32 v[212:213], v[68:69], v[196:197] op_sel:[0,1] op_sel_hi:[1,1]
  v_pk_mul_f32 v[214:215], v[70:71], v[196:197] op_sel:[0,1] op_sel_hi:[1,1]
  buffer_load_dwordx4 a[228:231], v3, s[40:43], s54 offen offset:2048
  v_exp_f32 v208, v208
  v_exp_f32 v209, v209
  v_exp_f32 v210, v210
  v_exp_f32 v211, v211
  v_pk_mul_f32 v[64:65], v[64:65], v[112:113]
  v_pk_mul_f32 v[66:67], v[66:67], v[114:115]
  v_exp_f32 v212, v212
  v_exp_f32 v213, v213
  v_exp_f32 v214, v214
  v_exp_f32 v215, v215
  v_pk_mul_f32 v[68:69], v[68:69], v[116:117]
  v_pk_mul_f32 v[70:71], v[70:71], v[118:119]
  buffer_load_dwordx4 a[232:235], v3, s[40:43], s54 offen offset:3072
  v_pk_fma_f32 v[208:209], v[208:209], v[194:195], v[194:195] op_sel_hi:[1,0,0]
  v_pk_fma_f32 v[210:211], v[210:211], v[194:195], v[194:195] op_sel_hi:[1,0,0]
  v_pk_fma_f32 v[212:213], v[212:213], v[198:199], v[198:199] op_sel_hi:[1,0,0]
  v_pk_fma_f32 v[214:215], v[214:215], v[198:199], v[198:199] op_sel_hi:[1,0,0]
  v_rcp_f32 v208, v208
  v_rcp_f32 v209, v209
  v_rcp_f32 v210, v210
  v_rcp_f32 v211, v211
  v_rcp_f32 v212, v212
  v_rcp_f32 v213, v213
  v_rcp_f32 v214, v214
  v_rcp_f32 v215, v215
  buffer_load_dwordx4 a[236:239], v4, s[40:43], s54 offen
  s_sub_u32 s54, s54, 15360
  v_pk_mul_f32 v[64:65], v[64:65], v[208:209]
  v_pk_mul_f32 v[66:67], v[66:67], v[210:211]
  v_pk_mul_f32 v[68:69], v[68:69], v[212:213]
  v_pk_mul_f32 v[70:71], v[70:71], v[214:215]
  v_cvt_pk_bf16_f32 v248, v64, v65
  v_cvt_pk_bf16_f32 v249, v66, v67
  v_cvt_pk_bf16_f32 v250, v68, v69
  v_cvt_pk_bf16_f32 v251, v70, v71
  s_nop 0
  v_permlane32_swap_b32 v248, v250
  v_permlane32_swap_b32 v249, v251
  buffer_store_dwordx4 v[248:251], v20, s[20:23], s33 offen sc1
  v_pk_fma_f32 v[24:25], v[156:157], v[184:185], v[24:25] op_sel_hi:[1,0,1]
  v_pk_fma_f32 v[26:27], v[158:159], v[184:185], v[26:27] op_sel_hi:[1,0,1]
  v_pk_fma_f32 v[72:73], v[168:169], v[184:185], v[72:73] op_sel_hi:[1,0,1]
  v_pk_fma_f32 v[74:75], v[170:171], v[184:185], v[74:75] op_sel_hi:[1,0,1]
  v_pk_fma_f32 v[40:41], v[160:161], v[184:185], v[40:41] op_sel_hi:[1,0,1]
  v_pk_fma_f32 v[42:43], v[162:163], v[184:185], v[42:43] op_sel_hi:[1,0,1]
  v_pk_fma_f32 v[88:89], v[172:173], v[184:185], v[88:89] op_sel_hi:[1,0,1]
  v_pk_fma_f32 v[90:91], v[174:175], v[184:185], v[90:91] op_sel_hi:[1,0,1]
  v_pk_fma_f32 v[28:29], v[156:157], v[188:189], v[28:29] op_sel_hi:[1,0,1]
  v_pk_fma_f32 v[30:31], v[158:159], v[188:189], v[30:31] op_sel_hi:[1,0,1]
  v_pk_fma_f32 v[76:77], v[168:169], v[188:189], v[76:77] op_sel_hi:[1,0,1]
  v_pk_fma_f32 v[78:79], v[170:171], v[188:189], v[78:79] op_sel_hi:[1,0,1]
  buffer_load_dwordx4 v[120:123], v16, s[44:47], s58 offen sc1
  v_pk_fma_f32 v[44:45], v[160:161], v[188:189], v[44:45] op_sel_hi:[1,0,1]
  v_pk_fma_f32 v[46:47], v[162:163], v[188:189], v[46:47] op_sel_hi:[1,0,1]
  v_pk_fma_f32 v[92:93], v[172:173], v[188:189], v[92:93] op_sel_hi:[1,0,1]
  v_pk_fma_f32 v[94:95], v[174:175], v[188:189], v[94:95] op_sel_hi:[1,0,1]
  v_pk_fma_f32 v[32:33], v[156:157], v[192:193], v[32:33] op_sel_hi:[1,0,1]
  v_pk_fma_f32 v[34:35], v[158:159], v[192:193], v[34:35] op_sel_hi:[1,0,1]
  v_pk_fma_f32 v[80:81], v[168:169], v[192:193], v[80:81] op_sel_hi:[1,0,1]
  v_pk_fma_f32 v[82:83], v[170:171], v[192:193], v[82:83] op_sel_hi:[1,0,1]
  v_pk_fma_f32 v[48:49], v[160:161], v[192:193], v[48:49] op_sel_hi:[1,0,1]
  v_pk_fma_f32 v[50:51], v[162:163], v[192:193], v[50:51] op_sel_hi:[1,0,1]
  v_pk_fma_f32 v[96:97], v[172:173], v[192:193], v[96:97] op_sel_hi:[1,0,1]
  v_pk_fma_f32 v[98:99], v[174:175], v[192:193], v[98:99] op_sel_hi:[1,0,1]
  buffer_load_dwordx4 v[124:127], v17, s[44:47], s58 offen sc1
  v_pk_fma_f32 v[36:37], v[156:157], v[196:197], v[36:37] op_sel_hi:[1,0,1]
  v_pk_fma_f32 v[38:39], v[158:159], v[196:197], v[38:39] op_sel_hi:[1,0,1]
  v_pk_fma_f32 v[84:85], v[168:169], v[196:197], v[84:85] op_sel_hi:[1,0,1]
  v_pk_fma_f32 v[86:87], v[170:171], v[196:197], v[86:87] op_sel_hi:[1,0,1]
  v_pk_fma_f32 v[52:53], v[160:161], v[196:197], v[52:53] op_sel_hi:[1,0,1]
  v_pk_fma_f32 v[54:55], v[162:163], v[196:197], v[54:55] op_sel_hi:[1,0,1]
  v_pk_fma_f32 v[100:101], v[172:173], v[196:197], v[100:101] op_sel_hi:[1,0,1]
  v_pk_fma_f32 v[102:103], v[174:175], v[196:197], v[102:103] op_sel_hi:[1,0,1]
  v_pk_mul_f32 v[208:209], v[24:25], v[184:185] op_sel:[0,1] op_sel_hi:[1,1]
  v_pk_mul_f32 v[210:211], v[26:27], v[184:185] op_sel:[0,1] op_sel_hi:[1,1]
  v_pk_mul_f32 v[212:213], v[40:41], v[184:185] op_sel:[0,1] op_sel_hi:[1,1]
  v_pk_mul_f32 v[214:215], v[42:43], v[184:185] op_sel:[0,1] op_sel_hi:[1,1]
  buffer_load_dwordx4 v[128:131], v18, s[44:47], s58 offen sc1
  v_exp_f32 v208, v208
  v_exp_f32 v209, v209
  v_exp_f32 v210, v210
  v_exp_f32 v211, v211
  v_pk_mul_f32 v[24:25], v[24:25], v[72:73]
  v_pk_mul_f32 v[26:27], v[26:27], v[74:75]
  v_exp_f32 v212, v212
  v_exp_f32 v213, v213
  v_exp_f32 v214, v214
  v_exp_f32 v215, v215
  v_pk_mul_f32 v[40:41], v[40:41], v[88:89]
  v_pk_mul_f32 v[42:43], v[42:43], v[90:91]
  buffer_load_dwordx4 v[132:135], v19, s[44:47], s58 offen sc1
  v_pk_fma_f32 v[208:209], v[208:209], v[186:187], v[186:187] op_sel_hi:[1,0,0]
  v_pk_fma_f32 v[210:211], v[210:211], v[186:187], v[186:187] op_sel_hi:[1,0,0]
  v_pk_fma_f32 v[212:213], v[212:213], v[186:187], v[186:187] op_sel_hi:[1,0,0]
  v_pk_fma_f32 v[214:215], v[214:215], v[186:187], v[186:187] op_sel_hi:[1,0,0]
  v_rcp_f32 v208, v208
  v_rcp_f32 v209, v209
  v_rcp_f32 v210, v210
  v_rcp_f32 v211, v211
  v_rcp_f32 v212, v212
  v_rcp_f32 v213, v213
  v_rcp_f32 v214, v214
  v_rcp_f32 v215, v215
  buffer_load_dwordx4 v[200:203], v16, s[44:47], s59 offen sc1
  v_pk_mul_f32 v[24:25], v[24:25], v[208:209]
  v_pk_mul_f32 v[26:27], v[26:27], v[210:211]
  v_pk_mul_f32 v[40:41], v[40:41], v[212:213]
  v_pk_mul_f32 v[42:43], v[42:43], v[214:215]
  v_cvt_pk_bf16_f32 v228, v24, v25
  v_cvt_pk_bf16_f32 v229, v26, v27
  v_cvt_pk_bf16_f32 v230, v40, v41
  v_cvt_pk_bf16_f32 v231, v42, v43
  buffer_store_dwordx4 v[228:231], v3, s[20:23], s30 offen offset:0 sc1
  v_pk_mul_f32 v[208:209], v[28:29], v[188:189] op_sel:[0,1] op_sel_hi:[1,1]
  v_pk_mul_f32 v[210:211], v[30:31], v[188:189] op_sel:[0,1] op_sel_hi:[1,1]
  v_pk_mul_f32 v[212:213], v[44:45], v[188:189] op_sel:[0,1] op_sel_hi:[1,1]
  v_pk_mul_f32 v[214:215], v[46:47], v[188:189] op_sel:[0,1] op_sel_hi:[1,1]
  v_exp_f32 v208, v208
  v_exp_f32 v209, v209
  v_exp_f32 v210, v210
  v_exp_f32 v211, v211
  v_pk_mul_f32 v[28:29], v[28:29], v[76:77]
  v_pk_mul_f32 v[30:31], v[30:31], v[78:79]
  v_exp_f32 v212, v212
  v_exp_f32 v213, v213
  buffer_load_dwordx4 v[204:207], v17, s[44:47], s59 offen sc1
  v_exp_f32 v214, v214
  v_exp_f32 v215, v215
  v_pk_mul_f32 v[44:45], v[44:45], v[92:93]
  v_pk_mul_f32 v[46:47], v[46:47], v[94:95]
  v_pk_fma_f32 v[208:209], v[208:209], v[190:191], v[190:191] op_sel_hi:[1,0,0]
  v_pk_fma_f32 v[210:211], v[210:211], v[190:191], v[190:191] op_sel_hi:[1,0,0]
  v_pk_fma_f32 v[212:213], v[212:213], v[190:191], v[190:191] op_sel_hi:[1,0,0]
  v_pk_fma_f32 v[214:215], v[214:215], v[190:191], v[190:191] op_sel_hi:[1,0,0]
  v_rcp_f32 v208, v208
  v_rcp_f32 v209, v209
  v_rcp_f32 v210, v210
  v_rcp_f32 v211, v211
  buffer_load_dwordx4 v[220:223], v18, s[44:47], s59 offen sc1
  v_rcp_f32 v212, v212
  v_rcp_f32 v213, v213
  v_rcp_f32 v214, v214
  v_rcp_f32 v215, v215
  v_pk_mul_f32 v[28:29], v[28:29], v[208:209]
  v_pk_mul_f32 v[30:31], v[30:31], v[210:211]
  v_pk_mul_f32 v[44:45], v[44:45], v[212:213]
  v_pk_mul_f32 v[46:47], v[46:47], v[214:215]
  v_cvt_pk_bf16_f32 v232, v28, v29
  v_cvt_pk_bf16_f32 v233, v30, v31
  v_cvt_pk_bf16_f32 v234, v44, v45
  v_cvt_pk_bf16_f32 v235, v46, v47
  buffer_store_dwordx4 v[232:235], v3, s[20:23], s30 offen offset:1024 sc1
  v_pk_mul_f32 v[208:209], v[32:33], v[192:193] op_sel:[0,1] op_sel_hi:[1,1]
  v_pk_mul_f32 v[210:211], v[34:35], v[192:193] op_sel:[0,1] op_sel_hi:[1,1]
  v_pk_mul_f32 v[212:213], v[48:49], v[192:193] op_sel:[0,1] op_sel_hi:[1,1]
  v_pk_mul_f32 v[214:215], v[50:51], v[192:193] op_sel:[0,1] op_sel_hi:[1,1]
  v_exp_f32 v208, v208
  v_exp_f32 v209, v209
  v_exp_f32 v210, v210
  v_exp_f32 v211, v211
  v_pk_mul_f32 v[32:33], v[32:33], v[80:81]
  v_pk_mul_f32 v[34:35], v[34:35], v[82:83]
  v_exp_f32 v212, v212
  v_exp_f32 v213, v213
  buffer_load_dwordx4 v[224:227], v19, s[44:47], s59 offen sc1
  v_exp_f32 v214, v214
  v_exp_f32 v215, v215
  v_pk_mul_f32 v[48:49], v[48:49], v[96:97]
  v_pk_mul_f32 v[50:51], v[50:51], v[98:99]
  v_pk_fma_f32 v[208:209], v[208:209], v[194:195], v[194:195] op_sel_hi:[1,0,0]
  v_pk_fma_f32 v[210:211], v[210:211], v[194:195], v[194:195] op_sel_hi:[1,0,0]
  v_pk_fma_f32 v[212:213], v[212:213], v[194:195], v[194:195] op_sel_hi:[1,0,0]
  v_pk_fma_f32 v[214:215], v[214:215], v[194:195], v[194:195] op_sel_hi:[1,0,0]
  v_rcp_f32 v208, v208
  v_rcp_f32 v209, v209
  v_rcp_f32 v210, v210
  v_rcp_f32 v211, v211
  buffer_load_dwordx4 v[56:59], v16, s[44:47], s60 offen sc1
  v_rcp_f32 v212, v212
  v_rcp_f32 v213, v213
  v_rcp_f32 v214, v214
  v_rcp_f32 v215, v215
  v_pk_mul_f32 v[32:33], v[32:33], v[208:209]
  v_pk_mul_f32 v[34:35], v[34:35], v[210:211]
  v_pk_mul_f32 v[48:49], v[48:49], v[212:213]
  v_pk_mul_f32 v[50:51], v[50:51], v[214:215]
  v_cvt_pk_bf16_f32 v236, v32, v33
  v_cvt_pk_bf16_f32 v237, v34, v35
  v_cvt_pk_bf16_f32 v238, v48, v49
  v_cvt_pk_bf16_f32 v239, v50, v51
  buffer_store_dwordx4 v[236:239], v3, s[20:23], s31 offen offset:0 sc1
  v_pk_mul_f32 v[208:209], v[36:37], v[196:197] op_sel:[0,1] op_sel_hi:[1,1]
  v_pk_mul_f32 v[210:211], v[38:39], v[196:197] op_sel:[0,1] op_sel_hi:[1,1]
  v_pk_mul_f32 v[212:213], v[52:53], v[196:197] op_sel:[0,1] op_sel_hi:[1,1]
  v_pk_mul_f32 v[214:215], v[54:55], v[196:197] op_sel:[0,1] op_sel_hi:[1,1]
  v_exp_f32 v208, v208
  v_exp_f32 v209, v209
  v_exp_f32 v210, v210
  v_exp_f32 v211, v211
  v_pk_mul_f32 v[36:37], v[36:37], v[84:85]
  v_pk_mul_f32 v[38:39], v[38:39], v[86:87]
  v_exp_f32 v212, v212
  v_exp_f32 v213, v213
  buffer_load_dwordx4 v[60:63], v17, s[44:47], s60 offen sc1
  v_exp_f32 v214, v214
  v_exp_f32 v215, v215
  v_pk_mul_f32 v[52:53], v[52:53], v[100:101]
  v_pk_mul_f32 v[54:55], v[54:55], v[102:103]
  v_pk_fma_f32 v[208:209], v[208:209], v[198:199], v[198:199] op_sel_hi:[1,0,0]
  v_pk_fma_f32 v[210:211], v[210:211], v[198:199], v[198:199] op_sel_hi:[1,0,0]
  v_pk_fma_f32 v[212:213], v[212:213], v[198:199], v[198:199] op_sel_hi:[1,0,0]
  v_pk_fma_f32 v[214:215], v[214:215], v[198:199], v[198:199] op_sel_hi:[1,0,0]
  v_rcp_f32 v208, v208
  v_rcp_f32 v209, v209
  v_rcp_f32 v210, v210
  v_rcp_f32 v211, v211
  buffer_load_dwordx4 v[64:67], v18, s[44:47], s60 offen sc1
  v_rcp_f32 v212, v212
  v_rcp_f32 v213, v213
  v_rcp_f32 v214, v214
  v_rcp_f32 v215, v215
  v_pk_mul_f32 v[36:37], v[36:37], v[208:209]
  v_pk_mul_f32 v[38:39], v[38:39], v[210:211]
  v_pk_mul_f32 v[52:53], v[52:53], v[212:213]
  v_pk_mul_f32 v[54:55], v[54:55], v[214:215]
  v_cvt_pk_bf16_f32 v240, v36, v37
  v_cvt_pk_bf16_f32 v241, v38, v39
  v_cvt_pk_bf16_f32 v242, v52, v53
  v_cvt_pk_bf16_f32 v243, v54, v55
  buffer_store_dwordx4 v[240:243], v3, s[20:23], s31 offen offset:1024 sc1
  s_waitcnt vmcnt(14)
  v_max3_u32 v21, v120, v121, v122
  s_waitcnt vmcnt(13)
  v_max3_u32 v21, v21, v123, v124
  v_max3_u32 v21, v21, v125, v126
  s_waitcnt vmcnt(12)
  v_max3_u32 v21, v21, v127, v128
  v_max3_u32 v21, v21, v129, v130
  s_waitcnt vmcnt(11)
  v_max3_u32 v21, v21, v131, v132
  v_max3_u32 v21, v21, v133, v134
  v_max_u32 v21, v21, v135
  v_cmp_eq_u32 vcc, -1, v21
  s_nop 1
  s_cbranch_vccnz L2_st0
L2_bk0:
  v_mfma_f32_16x16x32_bf16 v[24:27], a[0:3], v[120:123], 0
  v_mfma_f32_16x16x32_bf16 v[40:43], a[4:7], v[120:123], 0
  buffer_load_dwordx4 v[68:71], v19, s[44:47], s60 offen sc1
  v_mfma_f32_16x16x32_bf16 v[72:75], a[8:11], v[120:123], 0
  v_mfma_f32_16x16x32_bf16 v[88:91], a[12:15], v[120:123], 0
  v_mfma_f32_16x16x32_bf16 v[184:187], a[16:19], v[120:123], 0
  v_mfma_f32_16x16x32_bf16 v[28:31], a[0:3], v[124:127], 0
  buffer_load_dwordx4 v[104:107], v16, s[44:47], s61 offen sc1
  v_mfma_f32_16x16x32_bf16 v[44:47], a[4:7], v[124:127], 0
  v_mfma_f32_16x16x32_bf16 v[76:79], a[8:11], v[124:127], 0
  v_mfma_f32_16x16x32_bf16 v[92:95], a[12:15], v[124:127], 0
  v_mfma_f32_16x16x32_bf16 v[188:191], a[16:19], v[124:127], 0
  buffer_load_dwordx4 v[108:111], v17, s[44:47], s61 offen sc1
  v_mfma_f32_16x16x32_bf16 v[32:35], a[0:3], v[128:131], 0
  s_waitcnt vmcnt(13)
  v_max3_u32 v21, v200, v201, v202
  v_mfma_f32_16x16x32_bf16 v[48:51], a[4:7], v[128:131], 0
  s_waitcnt vmcnt(11)
  v_max3_u32 v21, v21, v203, v204
  v_mfma_f32_16x16x32_bf16 v[80:83], a[8:11], v[128:131], 0
  v_max3_u32 v21, v21, v205, v206
  v_mfma_f32_16x16x32_bf16 v[96:99], a[12:15], v[128:131], 0
  buffer_load_dwordx4 v[112:115], v18, s[44:47], s61 offen sc1
  s_waitcnt vmcnt(11)
  v_max3_u32 v21, v21, v207, v220
  v_mfma_f32_16x16x32_bf16 v[192:195], a[16:19], v[128:131], 0
  v_max3_u32 v21, v21, v221, v222
  v_mfma_f32_16x16x32_bf16 v[36:39], a[0:3], v[132:135], 0
  s_waitcnt vmcnt(9)
  v_max3_u32 v21, v21, v223, v224
  v_mfma_f32_16x16x32_bf16 v[52:55], a[4:7], v[132:135], 0
  v_max3_u32 v21, v21, v225, v226
  v_mfma_f32_16x16x32_bf16 v[84:87], a[8:11], v[132:135], 0
  buffer_load_dwordx4 v[116:119], v19, s[44:47], s61 offen sc1
  v_max_u32 v21, v21, v227
  v_mfma_f32_16x16x32_bf16 v[100:103], a[12:15], v[132:135], 0
  v_cmp_eq_u32 vcc, -1, v21
  v_mfma_f32_16x16x32_bf16 v[196:199], a[16:19], v[132:135], 0
  s_cbranch_vccnz L2_st1
L2_bk1:
  v_mfma_f32_16x16x32_bf16 v[24:27], a[20:23], v[200:203], v[24:27]
  v_mfma_f32_16x16x32_bf16 v[40:43], a[24:27], v[200:203], v[40:43]
  buffer_load_dwordx4 v[156:159], v16, s[44:47], s62 offen sc1
  v_mfma_f32_16x16x32_bf16 v[72:75], a[28:31], v[200:203], v[72:75]
  v_mfma_f32_16x16x32_bf16 v[88:91], a[32:35], v[200:203], v[88:91]
  v_mfma_f32_16x16x32_bf16 v[184:187], a[36:39], v[200:203], v[184:187]
  v_mfma_f32_16x16x32_bf16 v[28:31], a[20:23], v[204:207], v[28:31]
  buffer_load_dwordx4 v[160:163], v17, s[44:47], s62 offen sc1
  v_mfma_f32_16x16x32_bf16 v[44:47], a[24:27], v[204:207], v[44:47]
  v_mfma_f32_16x16x32_bf16 v[76:79], a[28:31], v[204:207], v[76:79]
  v_mfma_f32_16x16x32_bf16 v[92:95], a[32:35], v[204:207], v[92:95]
  v_mfma_f32_16x16x32_bf16 v[188:191], a[36:39], v[204:207], v[188:191]
  buffer_load_dwordx4 v[164:167], v18, s[44:47], s62 offen sc1
  v_mfma_f32_16x16x32_bf16 v[32:35], a[20:23], v[220:223], v[32:35]
  s_waitcnt vmcnt(12)
  v_max3_u32 v21, v56, v57, v58
  v_mfma_f32_16x16x32_bf16 v[48:51], a[24:27], v[220:223], v[48:51]
  s_waitcnt vmcnt(10)
  v_max3_u32 v21, v21, v59, v60
  v_mfma_f32_16x16x32_bf16 v[80:83], a[28:31], v[220:223], v[80:83]
  v_max3_u32 v21, v21, v61, v62
  v_mfma_f32_16x16x32_bf16 v[96:99], a[32:35], v[220:223], v[96:99]
  buffer_load_dwordx4 v[168:171], v19, s[44:47], s62 offen sc1
  s_waitcnt vmcnt(10)
  v_max3_u32 v21, v21, v63, v64
  v_mfma_f32_16x16x32_bf16 v[192:195], a[36:39], v[220:223], v[192:195]
  v_max3_u32 v21, v21, v65, v66
  v_mfma_f32_16x16x32_bf16 v[36:39], a[20:23], v[224:227], v[36:39]
  s_waitcnt vmcnt(8)
  v_max3_u32 v21, v21, v67, v68
  v_mfma_f32_16x16x32_bf16 v[52:55], a[24:27], v[224:227], v[52:55]
  v_max3_u32 v21, v21, v69, v70
  v_mfma_f32_16x16x32_bf16 v[84:87], a[28:31], v[224:227], v[84:87]
  buffer_load_dwordx4 v[172:175], v16, s[44:47], s63 offen sc1
  v_max_u32 v21, v21, v71
  v_mfma_f32_16x16x32_bf16 v[100:103], a[32:35], v[224:227], v[100:103]
  v_cmp_eq_u32 vcc, -1, v21
  v_mfma_f32_16x16x32_bf16 v[196:199], a[36:39], v[224:227], v[196:199]
  s_cbranch_vccnz L2_st2
L2_bk2:
  v_mfma_f32_16x16x32_bf16 v[24:27], a[40:43], v[56:59], v[24:27]
  v_mfma_f32_16x16x32_bf16 v[40:43], a[44:47], v[56:59], v[40:43]
  buffer_load_dwordx4 v[176:179], v17, s[44:47], s63 offen sc1
  v_mfma_f32_16x16x32_bf16 v[72:75], a[48:51], v[56:59], v[72:75]
  v_mfma_f32_16x16x32_bf16 v[88:91], a[52:55], v[56:59], v[88:91]
  v_mfma_f32_16x16x32_bf16 v[184:187], a[56:59], v[56:59], v[184:187]
  v_mfma_f32_16x16x32_bf16 v[28:31], a[40:43], v[60:63], v[28:31]
  buffer_load_dwordx4 v[180:183], v18, s[44:47], s63 offen sc1
  v_mfma_f32_16x16x32_bf16 v[44:47], a[44:47], v[60:63], v[44:47]
  v_mfma_f32_16x16x32_bf16 v[76:79], a[48:51], v[60:63], v[76:79]
  v_mfma_f32_16x16x32_bf16 v[92:95], a[52:55], v[60:63], v[92:95]
  v_mfma_f32_16x16x32_bf16 v[188:191], a[56:59], v[60:63], v[188:191]
  buffer_load_dwordx4 v[252:255], v19, s[44:47], s63 offen sc1
  v_mfma_f32_16x16x32_bf16 v[32:35], a[40:43], v[64:67], v[32:35]
  s_waitcnt vmcnt(11)
  v_max3_u32 v21, v104, v105, v106
  v_mfma_f32_16x16x32_bf16 v[48:51], a[44:47], v[64:67], v[48:51]
  s_waitcnt vmcnt(10)
  v_max3_u32 v21, v21, v107, v108
  v_mfma_f32_16x16x32_bf16 v[80:83], a[48:51], v[64:67], v[80:83]
  v_max3_u32 v21, v21, v109, v110
  v_mfma_f32_16x16x32_bf16 v[96:99], a[52:55], v[64:67], v[96:99]
  buffer_load_dwordx4 v[244:247], v16, s[44:47], s64 offen sc1
  s_waitcnt vmcnt(10)
  v_max3_u32 v21, v21, v111, v112
  v_mfma_f32_16x16x32_bf16 v[192:195], a[56:59], v[64:67], v[192:195]
  v_max3_u32 v21, v21, v113, v114
  v_mfma_f32_16x16x32_bf16 v[36:39], a[40:43], v[68:71], v[36:39]
  s_waitcnt vmcnt(9)
  v_max3_u32 v21, v21, v115, v116
  v_mfma_f32_16x16x32_bf16 v[52:55], a[44:47], v[68:71], v[52:55]
  v_max3_u32 v21, v21, v117, v118
  v_mfma_f32_16x16x32_bf16 v[84:87], a[48:51], v[68:71], v[84:87]
  buffer_load_dwordx4 v[248:251], v17, s[44:47], s64 offen sc1
  v_max_u32 v21, v21, v119
  v_mfma_f32_16x16x32_bf16 v[100:103], a[52:55], v[68:71], v[100:103]
  v_cmp_eq_u32 vcc, -1, v21
  v_mfma_f32_16x16x32_bf16 v[196:199], a[56:59], v[68:71], v[196:199]
  s_cbranch_vccnz L2_st3
L2_bk3:
  v_mfma_f32_16x16x32_bf16 v[24:27], a[60:63], v[104:107], v[24:27]
  v_mfma_f32_16x16x32_bf16 v[40:43], a[64:67], v[104:107], v[40:43]
  buffer_load_dwordx4 v[208:211], v18, s[44:47], s64 offen sc1
  v_mfma_f32_16x16x32_bf16 v[72:75], a[68:71], v[104:107], v[72:75]
  v_mfma_f32_16x16x32_bf16 v[88:91], a[72:75], v[104:107], v[88:91]
  v_mfma_f32_16x16x32_bf16 v[184:187], a[76:79], v[104:107], v[184:187]
  v_mfma_f32_16x16x32_bf16 v[28:31], a[60:63], v[108:111], v[28:31]
  buffer_load_dwordx4 v[212:215], v19, s[44:47], s64 offen sc1
  v_mfma_f32_16x16x32_bf16 v[44:47], a[64:67], v[108:111], v[44:47]
  v_mfma_f32_16x16x32_bf16 v[76:79], a[68:71], v[108:111], v[76:79]
  v_mfma_f32_16x16x32_bf16 v[92:95], a[72:75], v[108:111], v[92:95]
  v_mfma_f32_16x16x32_bf16 v[188:191], a[76:79], v[108:111], v[188:191]
  buffer_load_dwordx4 v[228:231], v16, s[44:47], s65 offen sc1
  v_mfma_f32_16x16x32_bf16 v[32:35], a[60:63], v[112:115], v[32:35]
  s_waitcnt vmcnt(12)
  v_max3_u32 v21, v156, v157, v158
  v_mfma_f32_16x16x32_bf16 v[48:51], a[64:67], v[112:115], v[48:51]
  s_waitcnt vmcnt(11)
  v_max3_u32 v21, v21, v159, v160
  v_mfma_f32_16x16x32_bf16 v[80:83], a[68:71], v[112:115], v[80:83]
  v_max3_u32 v21, v21, v161, v162
  v_mfma_f32_16x16x32_bf16 v[96:99], a[72:75], v[112:115], v[96:99]
  buffer_load_dwordx4 v[232:235], v17, s[44:47], s65 offen sc1
  s_waitcnt vmcnt(11)
  v_max3_u32 v21, v21, v163, v164
  v_mfma_f32_16x16x32_bf16 v[192:195], a[76:79], v[112:115], v[192:195]
  v_max3_u32 v21, v21, v165, v166
  v_mfma_f32_16x16x32_bf16 v[36:39], a[60:63], v[116:119], v[36:39]
  s_waitcnt vmcnt(10)
  v_max3_u32 v21, v21, v167, v168
  v_mfma_f32_16x16x32_bf16 v[52:55], a[64:67], v[116:119], v[52:55]
  v_max3_u32 v21, v21, v169, v170
  v_mfma_f32_16x16x32_bf16 v[84:87], a[68:71], v[116:119], v[84:87]
  buffer_load_dwordx4 v[236:239], v18, s[44:47], s65 offen sc1
  v_max_u32 v21, v21, v171
  v_mfma_f32_16x16x32_bf16 v[100:103], a[72:75], v[116:119], v[100:103]
  v_cmp_eq_u32 vcc, -1, v21
  v_mfma_f32_16x16x32_bf16 v[196:199], a[76:79], v[116:119], v[196:199]
  s_cbranch_vccnz L2_st4
L2_bk4:
  v_mfma_f32_16x16x32_bf16 v[24:27], a[80:83], v[156:159], v[24:27]
  v_mfma_f32_16x16x32_bf16 v[40:43], a[84:87], v[156:159], v[40:43]
  buffer_load_dwordx4 v[240:243], v19, s[44:47], s65 offen sc1
  v_mfma_f32_16x16x32_bf16 v[72:75], a[88:91], v[156:159], v[72:75]
  v_mfma_f32_16x16x32_bf16 v[88:91], a[92:95], v[156:159], v[88:91]
  v_mfma_f32_16x16x32_bf16 v[184:187], a[96:99], v[156:159], v[184:187]
  v_mfma_f32_16x16x32_bf16 v[28:31], a[80:83], v[160:163], v[28:31]
  buffer_load_dwordx4 v[120:123], v16, s[44:47], s66 offen sc1
  v_mfma_f32_16x16x32_bf16 v[44:47], a[84:87], v[160:163], v[44:47]
  v_mfma_f32_16x16x32_bf16 v[76:79], a[88:91], v[160:163], v[76:79]
  v_mfma_f32_16x16x32_bf16 v[92:95], a[92:95], v[160:163], v[92:95]
  v_mfma_f32_16x16x32_bf16 v[188:191], a[96:99], v[160:163], v[188:191]
  buffer_load_dwordx4 v[124:127], v17, s[44:47], s66 offen sc1
  v_mfma_f32_16x16x32_bf16 v[32:35], a[80:83], v[164:167], v[32:35]
  s_waitcnt vmcnt(13)
  v_max3_u32 v21, v172, v173, v174
  v_mfma_f32_16x16x32_bf16 v[48:51], a[84:87], v[164:167], v[48:51]
  s_waitcnt vmcnt(12)
  v_max3_u32 v21, v21, v175, v176
  v_mfma_f32_16x16x32_bf16 v[80:83], a[88:91], v[164:167], v[80:83]
  v_max3_u32 v21, v21, v177, v178
  v_mfma_f32_16x16x32_bf16 v[96:99], a[92:95], v[164:167], v[96:99]
  buffer_load_dwordx4 v[128:131], v18, s[44:47], s66 offen sc1
  s_waitcnt vmcnt(12)
  v_max3_u32 v21, v21, v179, v180
  v_mfma_f32_16x16x32_bf16 v[192:195], a[96:99], v[164:167], v[192:195]
  v_max3_u32 v21, v21, v181, v182
  v_mfma_f32_16x16x32_bf16 v[36:39], a[80:83], v[168:171], v[36:39]
  s_waitcnt vmcnt(11)
  v_max3_u32 v21, v21, v183, v252
  v_mfma_f32_16x16x32_bf16 v[52:55], a[84:87], v[168:171], v[52:55]
  v_max3_u32 v21, v21, v253, v254
  v_mfma_f32_16x16x32_bf16 v[84:87], a[88:91], v[168:171], v[84:87]
  buffer_load_dwordx4 v[132:135], v19, s[44:47], s66 offen sc1
  v_max_u32 v21, v21, v255
  v_mfma_f32_16x16x32_bf16 v[100:103], a[92:95], v[168:171], v[100:103]
  v_cmp_eq_u32 vcc, -1, v21
  v_mfma_f32_16x16x32_bf16 v[196:199], a[96:99], v[168:171], v[196:199]
  s_cbranch_vccnz L2_st5
L2_bk5:
  v_mfma_f32_16x16x32_bf16 v[24:27], a[100:103], v[172:175], v[24:27]
  v_mfma_f32_16x16x32_bf16 v[40:43], a[104:107], v[172:175], v[40:43]
  buffer_load_dwordx4 v[200:203], v16, s[44:47], s67 offen sc1
  v_mfma_f32_16x16x32_bf16 v[72:75], a[108:111], v[172:175], v[72:75]
  v_mfma_f32_16x16x32_bf16 v[88:91], a[112:115], v[172:175], v[88:91]
  v_mfma_f32_16x16x32_bf16 v[184:187], a[116:119], v[172:175], v[184:187]
  v_mfma_f32_16x16x32_bf16 v[28:31], a[100:103], v[176:179], v[28:31]
  buffer_load_dwordx4 v[204:207], v17, s[44:47], s67 offen sc1
  v_mfma_f32_16x16x32_bf16 v[44:47], a[104:107], v[176:179], v[44:47]
  v_mfma_f32_16x16x32_bf16 v[76:79], a[108:111], v[176:179], v[76:79]
  v_mfma_f32_16x16x32_bf16 v[92:95], a[112:115], v[176:179], v[92:95]
  v_mfma_f32_16x16x32_bf16 v[188:191], a[116:119], v[176:179], v[188:191]
  buffer_load_dwordx4 v[220:223], v18, s[44:47], s67 offen sc1
  v_mfma_f32_16x16x32_bf16 v[32:35], a[100:103], v[180:183], v[32:35]
  s_waitcnt vmcnt(14)
  v_max3_u32 v21, v244, v245, v246
  v_mfma_f32_16x16x32_bf16 v[48:51], a[104:107], v[180:183], v[48:51]
  s_waitcnt vmcnt(13)
  v_max3_u32 v21, v21, v247, v248
  v_mfma_f32_16x16x32_bf16 v[80:83], a[108:111], v[180:183], v[80:83]
  v_max3_u32 v21, v21, v249, v250
  v_mfma_f32_16x16x32_bf16 v[96:99], a[112:115], v[180:183], v[96:99]
  buffer_load_dwordx4 v[224:227], v19, s[44:47], s67 offen sc1
  s_waitcnt vmcnt(13)
  v_max3_u32 v21, v21, v251, v208
  v_mfma_f32_16x16x32_bf16 v[192:195], a[116:119], v[180:183], v[192:195]
  v_max3_u32 v21, v21, v209, v210
  v_mfma_f32_16x16x32_bf16 v[36:39], a[100:103], v[252:255], v[36:39]
  s_waitcnt vmcnt(12)
  v_max3_u32 v21, v21, v211, v212
  v_mfma_f32_16x16x32_bf16 v[52:55], a[104:107], v[252:255], v[52:55]
  v_max3_u32 v21, v21, v213, v214
  v_mfma_f32_16x16x32_bf16 v[84:87], a[108:111], v[252:255], v[84:87]
  buffer_load_dwordx4 v[56:59], v16, s[44:47], s68 offen sc1
  v_max_u32 v21, v21, v215
  v_mfma_f32_16x16x32_bf16 v[100:103], a[112:115], v[252:255], v[100:103]
  v_cmp_eq_u32 vcc, -1, v21
  v_mfma_f32_16x16x32_bf16 v[196:199], a[116:119], v[252:255], v[196:199]
  s_cbranch_vccnz L2_st6
L2_bk6:
  v_mfma_f32_16x16x32_bf16 v[24:27], a[120:123], v[244:247], v[24:27]
  v_mfma_f32_16x16x32_bf16 v[40:43], a[124:127], v[244:247], v[40:43]
  buffer_load_dwordx4 v[60:63], v17, s[44:47], s68 offen sc1
  v_mfma_f32_16x16x32_bf16 v[72:75], a[128:131], v[244:247], v[72:75]
  v_mfma_f32_16x16x32_bf16 v[88:91], a[132:135], v[244:247], v[88:91]
  v_mfma_f32_16x16x32_bf16 v[184:187], a[136:139], v[244:247], v[184:187]
  v_mfma_f32_16x16x32_bf16 v[28:31], a[120:123], v[248:251], v[28:31]
  buffer_load_dwordx4 v[64:67], v18, s[44:47], s68 offen sc1
  v_mfma_f32_16x16x32_bf16 v[44:47], a[124:127], v[248:251], v[44:47]
  v_mfma_f32_16x16x32_bf16 v[76:79], a[128:131], v[248:251], v[76:79]
  v_mfma_f32_16x16x32_bf16 v[92:95], a[132:135], v[248:251], v[92:95]
  v_mfma_f32_16x16x32_bf16 v[188:191], a[136:139], v[248:251], v[188:191]
  buffer_load_dwordx4 v[68:71], v19, s[44:47], s68 offen sc1
  v_mfma_f32_16x16x32_bf16 v[32:35], a[120:123], v[208:211], v[32:35]
  s_waitcnt vmcnt(15)
  v_max3_u32 v21, v228, v229, v230
  v_mfma_f32_16x16x32_bf16 v[48:51], a[124:127], v[208:211], v[48:51]
  s_waitcnt vmcnt(14)
  v_max3_u32 v21, v21, v231, v232
  v_mfma_f32_16x16x32_bf16 v[80:83], a[128:131], v[208:211], v[80:83]
  v_max3_u32 v21, v21, v233, v234
  v_mfma_f32_16x16x32_bf16 v[96:99], a[132:135], v[208:211], v[96:99]
  buffer_load_dwordx4 v[104:107], v16, s[44:47], s69 offen sc1
  s_waitcnt vmcnt(14)
  v_max3_u32 v21, v21, v235, v236
  v_mfma_f32_16x16x32_bf16 v[192:195], a[136:139], v[208:211], v[192:195]
  v_max3_u32 v21, v21, v237, v238
  v_mfma_f32_16x16x32_bf16 v[36:39], a[120:123], v[212:215], v[36:39]
  s_waitcnt vmcnt(13)
  v_max3_u32 v21, v21, v239, v240
  v_mfma_f32_16x16x32_bf16 v[52:55], a[124:127], v[212:215], v[52:55]
  v_max3_u32 v21, v21, v241, v242
  v_mfma_f32_16x16x32_bf16 v[84:87], a[128:131], v[212:215], v[84:87]
  buffer_load_dwordx4 v[108:111], v17, s[44:47], s69 offen sc1
  v_max_u32 v21, v21, v243
  v_mfma_f32_16x16x32_bf16 v[100:103], a[132:135], v[212:215], v[100:103]
  v_cmp_eq_u32 vcc, -1, v21
  v_mfma_f32_16x16x32_bf16 v[196:199], a[136:139], v[212:215], v[196:199]
  s_cbranch_vccnz L2_st7
L2_bk7:
  v_mfma_f32_16x16x32_bf16 v[24:27], a[140:143], v[228:231], v[24:27]
  v_mfma_f32_16x16x32_bf16 v[40:43], a[144:147], v[228:231], v[40:43]
  buffer_load_dwordx4 v[112:115], v18, s[44:47], s69 offen sc1
  v_mfma_f32_16x16x32_bf16 v[72:75], a[148:151], v[228:231], v[72:75]
  v_mfma_f32_16x16x32_bf16 v[88:91], a[152:155], v[228:231], v[88:91]
  v_mfma_f32_16x16x32_bf16 v[184:187], a[156:159], v[228:231], v[184:187]
  v_mfma_f32_16x16x32_bf16 v[28:31], a[140:143], v[232:235], v[28:31]
  buffer_load_dwordx4 v[116:119], v19, s[44:47], s69 offen sc1
  v_mfma_f32_16x16x32_bf16 v[44:47], a[144:147], v[232:235], v[44:47]
  v_mfma_f32_16x16x32_bf16 v[76:79], a[148:151], v[232:235], v[76:79]
  v_mfma_f32_16x16x32_bf16 v[92:95], a[152:155], v[232:235], v[92:95]
  v_mfma_f32_16x16x32_bf16 v[188:191], a[156:159], v[232:235], v[188:191]
  buffer_load_dwordx4 v[156:159], v16, s[44:47], s70 offen sc1
  v_mfma_f32_16x16x32_bf16 v[32:35], a[140:143], v[236:239], v[32:35]
  s_waitcnt vmcnt(16)
  v_max3_u32 v21, v120, v121, v122
  v_mfma_f32_16x16x32_bf16 v[48:51], a[144:147], v[236:239], v[48:51]
  s_waitcnt vmcnt(15)
  v_max3_u32 v21, v21, v123, v124
  v_mfma_f32_16x16x32_bf16 v[80:83], a[148:151], v[236:239], v[80:83]
  v_max3_u32 v21, v21, v125, v126
  v_mfma_f32_16x16x32_bf16 v[96:99], a[152:155], v[236:239], v[96:99]
  buffer_load_dwordx4 v[160:163], v17, s[44:47], s70 offen sc1
  s_waitcnt vmcnt(15)
  v_max3_u32 v21, v21, v127, v128
  v_mfma_f32_16x16x32_bf16 v[192:195], a[156:159], v[236:239], v[192:195]
  v_max3_u32 v21, v21, v129, v130
  v_mfma_f32_16x16x32_bf16 v[36:39], a[140:143], v[240:243], v[36:39]
  s_waitcnt vmcnt(14)
  v_max3_u32 v21, v21, v131, v132
  v_mfma_f32_16x16x32_bf16 v[52:55], a[144:147], v[240:243], v[52:55]
  v_max3_u32 v21, v21, v133, v134
  v_mfma_f32_16x16x32_bf16 v[84:87], a[148:151], v[240:243], v[84:87]
  buffer_load_dwordx4 v[164:167], v18, s[44:47], s70 offen sc1
  v_max_u32 v21, v21, v135
  v_mfma_f32_16x16x32_bf16 v[100:103], a[152:155], v[240:243], v[100:103]
  v_cmp_eq_u32 vcc, -1, v21
  v_mfma_f32_16x16x32_bf16 v[196:199], a[156:159], v[240:243], v[196:199]
  s_cbranch_vccnz L2_st8
L2_bk8:
  v_mfma_f32_16x16x32_bf16 v[24:27], a[160:163], v[120:123], v[24:27]
  v_mfma_f32_16x16x32_bf16 v[40:43], a[164:167], v[120:123], v[40:43]
  buffer_load_dwordx4 v[168:171], v19, s[44:47], s70 offen sc1
  v_mfma_f32_16x16x32_bf16 v[72:75], a[168:171], v[120:123], v[72:75]
  v_mfma_f32_16x16x32_bf16 v[88:91], a[172:175], v[120:123], v[88:91]
  v_mfma_f32_16x16x32_bf16 v[184:187], a[176:179], v[120:123], v[184:187]
  v_mfma_f32_16x16x32_bf16 v[28:31], a[160:163], v[124:127], v[28:31]
  buffer_load_dwordx4 v[172:175], v16, s[44:47], s71 offen sc1
  v_mfma_f32_16x16x32_bf16 v[44:47], a[164:167], v[124:127], v[44:47]
  v_mfma_f32_16x16x32_bf16 v[76:79], a[168:171], v[124:127], v[76:79]
  v_mfma_f32_16x16x32_bf16 v[92:95], a[172:175], v[124:127], v[92:95]
  v_mfma_f32_16x16x32_bf16 v[188:191], a[176:179], v[124:127], v[188:191]
  buffer_load_dwordx4 v[176:179], v17, s[44:47], s71 offen sc1
  v_mfma_f32_16x16x32_bf16 v[32:35], a[160:163], v[128:131], v[32:35]
  s_waitcnt vmcnt(17)
  v_max3_u32 v21, v200, v201, v202
  v_mfma_f32_16x16x32_bf16 v[48:51], a[164:167], v[128:131], v[48:51]
  s_waitcnt vmcnt(16)
  v_max3_u32 v21, v21, v203, v204
  v_mfma_f32_16x16x32_bf16 v[80:83], a[168:171], v[128:131], v[80:83]
  v_max3_u32 v21, v21, v205, v206
  v_mfma_f32_16x16x32_bf16 v[96:99], a[172:175], v[128:131], v[96:99]
  buffer_load_dwordx4 v[180:183], v18, s[44:47], s71 offen sc1
  s_waitcnt vmcnt(16)
  v_max3_u32 v21, v21, v207, v220
  v_mfma_f32_16x16x32_bf16 v[192:195], a[176:179], v[128:131], v[192:195]
  v_max3_u32 v21, v21, v221, v222
  v_mfma_f32_16x16x32_bf16 v[36:39], a[160:163], v[132:135], v[36:39]
  s_waitcnt vmcnt(15)
  v_max3_u32 v21, v21, v223, v224
  v_mfma_f32_16x16x32_bf16 v[52:55], a[164:167], v[132:135], v[52:55]
  v_max3_u32 v21, v21, v225, v226
  v_mfma_f32_16x16x32_bf16 v[84:87], a[168:171], v[132:135], v[84:87]
  buffer_load_dwordx4 v[252:255], v19, s[44:47], s71 offen sc1
  v_max_u32 v21, v21, v227
  v_mfma_f32_16x16x32_bf16 v[100:103], a[172:175], v[132:135], v[100:103]
  v_cmp_eq_u32 vcc, -1, v21
  v_mfma_f32_16x16x32_bf16 v[196:199], a[176:179], v[132:135], v[196:199]
  s_cbranch_vccnz L2_st9
L2_bk9:
  v_mfma_f32_16x16x32_bf16 v[24:27], a[180:183], v[200:203], v[24:27]
  v_mfma_f32_16x16x32_bf16 v[40:43], a[184:187], v[200:203], v[40:43]
  buffer_load_dwordx4 a[240:243], v3, s[40:43], s54 offen
  v_mfma_f32_16x16x32_bf16 v[72:75], a[188:191], v[200:203], v[72:75]
  v_mfma_f32_16x16x32_bf16 v[88:91], a[192:195], v[200:203], v[88:91]
  v_mfma_f32_16x16x32_bf16 v[184:187], a[196:199], v[200:203], v[184:187]
  v_mfma_f32_16x16x32_bf16 v[28:31], a[180:183], v[204:207], v[28:31]
  buffer_load_dwordx4 a[244:247], v3, s[40:43], s54 offen offset:1024
  v_mfma_f32_16x16x32_bf16 v[44:47], a[184:187], v[204:207], v[44:47]
  v_mfma_f32_16x16x32_bf16 v[76:79], a[188:191], v[204:207], v[76:79]
  v_mfma_f32_16x16x32_bf16 v[92:95], a[192:195], v[204:207], v[92:95]
  v_mfma_f32_16x16x32_bf16 v[188:191], a[196:199], v[204:207], v[188:191]
  buffer_load_dwordx4 a[248:251], v3, s[40:43], s54 offen offset:2048
  v_mfma_f32_16x16x32_bf16 v[32:35], a[180:183], v[220:223], v[32:35]
  s_waitcnt vmcnt(18)
  v_max3_u32 v21, v56, v57, v58
  v_mfma_f32_16x16x32_bf16 v[48:51], a[184:187], v[220:223], v[48:51]
  s_waitcnt vmcnt(17)
  v_max3_u32 v21, v21, v59, v60
  v_mfma_f32_16x16x32_bf16 v[80:83], a[188:191], v[220:223], v[80:83]
  v_max3_u32 v21, v21, v61, v62
  v_mfma_f32_16x16x32_bf16 v[96:99], a[192:195], v[220:223], v[96:99]
  buffer_load_dwordx4 a[252:255], v3, s[40:43], s54 offen offset:3072
  s_waitcnt vmcnt(17)
  v_max3_u32 v21, v21, v63, v64
  v_mfma_f32_16x16x32_bf16 v[192:195], a[196:199], v[220:223], v[192:195]
  v_max3_u32 v21, v21, v65, v66
  v_mfma_f32_16x16x32_bf16 v[36:39], a[180:183], v[224:227], v[36:39]
  s_waitcnt vmcnt(16)
  v_max3_u32 v21, v21, v67, v68
  v_mfma_f32_16x16x32_bf16 v[52:55], a[184:187], v[224:227], v[52:55]
  v_max3_u32 v21, v21, v69, v70
  v_mfma_f32_16x16x32_bf16 v[84:87], a[188:191], v[224:227], v[84:87]
  buffer_load_dwordx4 v[136:139], v4, s[40:43], s54 offen
  s_add_u32 s54, s54, 20480
  v_max_u32 v21, v21, v71
  v_mfma_f32_16x16x32_bf16 v[100:103], a[192:195], v[224:227], v[100:103]
  v_cmp_eq_u32 vcc, -1, v21
  v_mfma_f32_16x16x32_bf16 v[196:199], a[196:199], v[224:227], v[196:199]
  s_cbranch_vccnz L2_st10
L2_bk10:
  v_mfma_f32_16x16x32_bf16 v[24:27], a[200:203], v[56:59], v[24:27]
  v_mfma_f32_16x16x32_bf16 v[40:43], a[204:207], v[56:59], v[40:43]
  buffer_load_dwordx4 v[140:143], v3, s[40:43], s54 offen
  v_mfma_f32_16x16x32_bf16 v[72:75], a[208:211], v[56:59], v[72:75]
  v_mfma_f32_16x16x32_bf16 v[88:91], a[212:215], v[56:59], v[88:91]
  v_mfma_f32_16x16x32_bf16 v[184:187], a[216:219], v[56:59], v[184:187]
  v_mfma_f32_16x16x32_bf16 v[28:31], a[200:203], v[60:63], v[28:31]
  buffer_load_dwordx4 v[144:147], v3, s[40:43], s54 offen offset:1024
  v_mfma_f32_16x16x32_bf16 v[44:47], a[204:207], v[60:63], v[44:47]
  v_mfma_f32_16x16x32_bf16 v[76:79], a[208:211], v[60:63], v[76:79]
  v_mfma_f32_16x16x32_bf16 v[92:95], a[212:215], v[60:63], v[92:95]
  v_mfma_f32_16x16x32_bf16 v[188:191], a[216:219], v[60:63], v[188:191]
  buffer_load_dwordx4 v[148:151], v3, s[40:43], s54 offen offset:2048
  v_mfma_f32_16x16x32_bf16 v[32:35], a[200:203], v[64:67], v[32:35]
  s_waitcnt vmcnt(19)
  v_max3_u32 v21, v104, v105, v106
  v_mfma_f32_16x16x32_bf16 v[48:51], a[204:207], v[64:67], v[48:51]
  s_waitcnt vmcnt(18)
  v_max3_u32 v21, v21, v107, v108
  v_mfma_f32_16x16x32_bf16 v[80:83], a[208:211], v[64:67], v[80:83]
  v_max3_u32 v21, v21, v109, v110
  v_mfma_f32_16x16x32_bf16 v[96:99], a[212:215], v[64:67], v[96:99]
  buffer_load_dwordx4 v[152:155], v3, s[40:43], s54 offen offset:3072
  s_waitcnt vmcnt(18)
  v_max3_u32 v21, v21, v111, v112
  v_mfma_f32_16x16x32_bf16 v[192:195], a[216:219], v[64:67], v[192:195]
  v_max3_u32 v21, v21, v113, v114
  v_mfma_f32_16x16x32_bf16 v[36:39], a[200:203], v[68:71], v[36:39]
  s_waitcnt vmcnt(17)
  v_max3_u32 v21, v21, v115, v116
  v_mfma_f32_16x16x32_bf16 v[52:55], a[204:207], v[68:71], v[52:55]
  v_max3_u32 v21, v21, v117, v118
  v_mfma_f32_16x16x32_bf16 v[84:87], a[208:211], v[68:71], v[84:87]
  buffer_load_dwordx4 v[216:219], v4, s[40:43], s54 offen
  v_max_u32 v21, v21, v119
  v_mfma_f32_16x16x32_bf16 v[100:103], a[212:215], v[68:71], v[100:103]
  v_cmp_eq_u32 vcc, -1, v21
  v_mfma_f32_16x16x32_bf16 v[196:199], a[216:219], v[68:71], v[196:199]
  s_cbranch_vccnz L2_st11
L2_bk11:
  v_mfma_f32_16x16x32_bf16 v[24:27], a[220:223], v[104:107], v[24:27]
  v_lshrrev_b32 v11, 4, v2
  v_and_b32 v12, 15, v2
  v_mfma_f32_16x16x32_bf16 v[40:43], a[224:227], v[104:107], v[40:43]
  s_movk_i32 s30, 640
  v_mul_u32_u24 v13, s30, v11
  v_mfma_f32_16x16x32_bf16 v[72:75], a[228:231], v[104:107], v[72:75]
  v_lshl_add_u32 v13, v12, 3, v13
  v_add_u32 v13, s57, v13
  v_mfma_f32_16x16x32_bf16 v[88:91], a[232:235], v[104:107], v[88:91]
  s_lshl_b32 s30, s52, 6
  s_lshl4_add_u32 s30, s3, s30
  v_mfma_f32_16x16x32_bf16 v[184:187], a[236:239], v[104:107], v[184:187]
  v_add_u32 v14, s30, v12
  s_movk_i32 s30, 1280
  v_mfma_f32_16x16x32_bf16 v[28:31], a[220:223], v[108:111], v[28:31]
  v_mul_u32_u24 v14, s30, v14
  v_mul_u32_u24 v11, 40, v11
  v_mfma_f32_16x16x32_bf16 v[44:47], a[224:227], v[108:111], v[44:47]
  v_add_u32 v14, v14, v11
  s_mul_i32 s31, s53, 160
  v_mfma_f32_16x16x32_bf16 v[76:79], a[228:231], v[108:111], v[76:79]
  s_xor_b32 s25, s3, 1
  s_mul_i32 s25, s25, 15360
  v_mfma_f32_16x16x32_bf16 v[92:95], a[232:235], v[108:111], v[92:95]
  v_mfma_f32_16x16x32_bf16 v[188:191], a[236:239], v[108:111], v[188:191]
  v_mfma_f32_16x16x32_bf16 v[32:35], a[220:223], v[112:115], v[32:35]
  s_waitcnt vmcnt(17)
  v_max3_u32 v21, v156, v157, v158
  v_mfma_f32_16x16x32_bf16 v[48:51], a[224:227], v[112:115], v[48:51]
  s_waitcnt vmcnt(16)
  v_max3_u32 v21, v21, v159, v160
  v_mfma_f32_16x16x32_bf16 v[80:83], a[228:231], v[112:115], v[80:83]
  v_max3_u32 v21, v21, v161, v162
  v_mfma_f32_16x16x32_bf16 v[96:99], a[232:235], v[112:115], v[96:99]
  s_waitcnt vmcnt(15)
  v_max3_u32 v21, v21, v163, v164
  v_mfma_f32_16x16x32_bf16 v[192:195], a[236:239], v[112:115], v[192:195]
  v_max3_u32 v21, v21, v165, v166
  v_mfma_f32_16x16x32_bf16 v[36:39], a[220:223], v[116:119], v[36:39]
  s_waitcnt vmcnt(14)
  v_max3_u32 v21, v21, v167, v168
  v_mfma_f32_16x16x32_bf16 v[52:55], a[224:227], v[116:119], v[52:55]
  v_max3_u32 v21, v21, v169, v170
  v_mfma_f32_16x16x32_bf16 v[84:87], a[228:231], v[116:119], v[84:87]
  v_max_u32 v21, v21, v171
  v_mfma_f32_16x16x32_bf16 v[100:103], a[232:235], v[116:119], v[100:103]
  v_cmp_eq_u32 vcc, -1, v21
  v_mfma_f32_16x16x32_bf16 v[196:199], a[236:239], v[116:119], v[196:199]
  s_cbranch_vccnz L2_st12
L2_bk12:
  s_waitcnt vmcnt(9)
  v_mfma_f32_16x16x32_bf16 v[24:27], a[240:243], v[156:159], v[24:27]
  s_add_u32 s25, s25, 0
  v_add_u32 v6, s25, v3
  s_waitcnt vmcnt(8)
  v_mfma_f32_16x16x32_bf16 v[40:43], a[244:247], v[156:159], v[40:43]
  s_xor_b32 s25, s3, 2
  s_mul_i32 s25, s25, 15360
  s_waitcnt vmcnt(7)
  v_mfma_f32_16x16x32_bf16 v[72:75], a[248:251], v[156:159], v[72:75]
  s_add_u32 s25, s25, 5120
  v_add_u32 v7, s25, v3
  s_waitcnt vmcnt(6)
  v_mfma_f32_16x16x32_bf16 v[88:91], a[252:255], v[156:159], v[88:91]
  s_xor_b32 s25, s3, 3
  s_mul_i32 s25, s25, 15360
  s_waitcnt vmcnt(5)
  v_mfma_f32_16x16x32_bf16 v[184:187], v[136:139], v[156:159], v[184:187]
  s_add_u32 s25, s25, 10240
  v_add_u32 v8, s25, v3
  v_mfma_f32_16x16x32_bf16 v[28:31], a[240:243], v[160:163], v[28:31]
  s_mul_i32 s25, s3, 15360
  v_add_u32 v5, s25, v3
  v_mfma_f32_16x16x32_bf16 v[44:47], a[244:247], v[160:163], v[44:47]
  s_mov_b32 s32, 0xffff0000
  v_mfma_f32_16x16x32_bf16 v[76:79], a[248:251], v[160:163], v[76:79]
  v_mfma_f32_16x16x32_bf16 v[92:95], a[252:255], v[160:163], v[92:95]
  v_mfma_f32_16x16x32_bf16 v[188:191], v[136:139], v[160:163], v[188:191]
  v_mfma_f32_16x16x32_bf16 v[32:35], a[240:243], v[164:167], v[32:35]
  v_max3_u32 v21, v172, v173, v174
  v_mfma_f32_16x16x32_bf16 v[48:51], a[244:247], v[164:167], v[48:51]
  v_max3_u32 v21, v21, v175, v176
  v_mfma_f32_16x16x32_bf16 v[80:83], a[248:251], v[164:167], v[80:83]
  v_max3_u32 v21, v21, v177, v178
  v_mfma_f32_16x16x32_bf16 v[96:99], a[252:255], v[164:167], v[96:99]
  v_max3_u32 v21, v21, v179, v180
  v_mfma_f32_16x16x32_bf16 v[192:195], v[136:139], v[164:167], v[192:195]
  v_max3_u32 v21, v21, v181, v182
  v_mfma_f32_16x16x32_bf16 v[36:39], a[240:243], v[168:171], v[36:39]
  v_max3_u32 v21, v21, v183, v252
  v_mfma_f32_16x16x32_bf16 v[52:55], a[244:247], v[168:171], v[52:55]
  v_max3_u32 v21, v21, v253, v254
  v_mfma_f32_16x16x32_bf16 v[84:87], a[248:251], v[168:171], v[84:87]
  v_max_u32 v21, v21, v255
  v_mfma_f32_16x16x32_bf16 v[100:103], a[252:255], v[168:171], v[100:103]
  v_cmp_eq_u32 vcc, -1, v21
  v_mfma_f32_16x16x32_bf16 v[196:199], v[136:139], v[168:171], v[196:199]
  s_cbranch_vccnz L2_st13
L2_bk13:
  s_waitcnt vmcnt(4)
  v_mfma_f32_16x16x32_bf16 v[28:31], v[140:143], v[176:179], v[28:31]
  s_waitcnt vmcnt(0)
  ds_read_b64_tr_b16 v[104:105], v13 offset:0
  v_mfma_f32_16x16x32_bf16 v[44:47], v[144:147], v[176:179], v[44:47]
  ds_read_b64_tr_b16 v[106:107], v13 offset:128
  v_mfma_f32_16x16x32_bf16 v[76:79], v[148:151], v[176:179], v[76:79]
  ds_read_b64_tr_b16 v[108:109], v13 offset:256
  v_mfma_f32_16x16x32_bf16 v[92:95], v[152:155], v[176:179], v[92:95]
  ds_read_b64_tr_b16 v[110:111], v13 offset:384
  ds_write_b128 v6, v[28:31] offset:0
  v_mfma_f32_16x16x32_bf16 v[188:191], v[216:219], v[176:179], v[188:191]
  ds_read_b64_tr_b16 v[112:113], v13 offset:512
  ds_write_b128 v6, v[44:47] offset:1024
  v_mfma_f32_16x16x32_bf16 v[32:35], v[140:143], v[180:183], v[32:35]
  ds_write_b128 v6, v[76:79] offset:2048
  v_mfma_f32_16x16x32_bf16 v[48:51], v[144:147], v[180:183], v[48:51]
  ds_write_b128 v6, v[92:95] offset:3072
  v_mfma_f32_16x16x32_bf16 v[80:83], v[148:151], v[180:183], v[80:83]
  s_nop 0
  ds_write_b128 v6, v[188:191] offset:4096
  v_mfma_f32_16x16x32_bf16 v[96:99], v[152:155], v[180:183], v[96:99]
  s_waitcnt lgkmcnt(9)
  v_lshlrev_b32 v116, 16, v104
  v_and_b32 v117, s32, v104
  ds_write_b128 v7, v[32:35] offset:0
  v_mfma_f32_16x16x32_bf16 v[192:195], v[216:219], v[180:183], v[192:195]
  v_lshlrev_b32 v118, 16, v105
  v_and_b32 v119, s32, v105
  ds_write_b128 v7, v[48:51] offset:1024
  v_mfma_f32_16x16x32_bf16 v[36:39], v[140:143], v[252:255], v[36:39]
  s_waitcnt lgkmcnt(10)
  v_lshlrev_b32 v120, 16, v106
  v_and_b32 v121, s32, v106
  ds_write_b128 v7, v[80:83] offset:2048
  v_mfma_f32_16x16x32_bf16 v[52:55], v[144:147], v[252:255], v[52:55]
  v_lshlrev_b32 v122, 16, v107
  v_and_b32 v123, s32, v107
  ds_write_b128 v7, v[96:99] offset:3072
  v_mfma_f32_16x16x32_bf16 v[84:87], v[148:151], v[252:255], v[84:87]
  s_waitcnt lgkmcnt(11)
  v_lshlrev_b32 v124, 16, v108
  v_and_b32 v125, s32, v108
  ds_write_b128 v7, v[192:195] offset:4096
  v_mfma_f32_16x16x32_bf16 v[100:103], v[152:155], v[252:255], v[100:103]
  v_lshlrev_b32 v126, 16, v109
  v_and_b32 v127, s32, v109
  ds_write_b128 v8, v[36:39] offset:0
  v_mfma_f32_16x16x32_bf16 v[196:199], v[216:219], v[252:255], v[196:199]
  s_waitcnt lgkmcnt(12)
  v_lshlrev_b32 v128, 16, v110
  v_and_b32 v129, s32, v110
  ds_write_b128 v8, v[52:55] offset:1024
  v_mfma_f32_16x16x32_bf16 v[24:27], v[140:143], v[172:175], v[24:27]
  v_lshlrev_b32 v130, 16, v111
  v_and_b32 v131, s32, v111
  ds_write_b128 v8, v[84:87] offset:2048
  v_mfma_f32_16x16x32_bf16 v[40:43], v[144:147], v[172:175], v[40:43]
  s_waitcnt lgkmcnt(12)
  v_lshlrev_b32 v132, 16, v112
  v_and_b32 v133, s32, v112
  ds_write_b128 v8, v[100:103] offset:3072
  v_mfma_f32_16x16x32_bf16 v[72:75], v[148:151], v[172:175], v[72:75]
  v_lshlrev_b32 v134, 16, v113
  v_and_b32 v135, s32, v113
  ds_write_b128 v8, v[196:199] offset:4096
  v_mfma_f32_16x16x32_bf16 v[88:91], v[152:155], v[172:175], v[88:91]
  v_mfma_f32_16x16x32_bf16 v[184:187], v[216:219], v[172:175], v[184:187]
  s_waitcnt lgkmcnt(0)
  s_barrier
  ds_read_b128 v[56:59], v5 offset:0
  ds_read_b128 v[60:63], v5 offset:5120
  ds_read_b128 v[64:67], v5 offset:10240
  ds_read_b128 v[156:159], v5 offset:1024
  ds_read_b128 v[160:163], v5 offset:6144
  ds_read_b128 v[164:167], v5 offset:11264
  ds_read_b128 v[200:203], v5 offset:2048
  ds_read_b128 v[204:207], v5 offset:7168
  ds_read_b128 v[208:211], v5 offset:12288
  ds_read_b128 v[228:231], v5 offset:3072
  ds_read_b128 v[232:235], v5 offset:8192
  ds_read_b128 v[236:239], v5 offset:13312
  ds_read_b128 v[240:243], v5 offset:4096
  ds_read_b128 v[244:247], v5 offset:9216
  ds_read_b128 v[248:251], v5 offset:14336
  v_pk_add_f32 v[24:25], v[24:25], v[116:117]
  v_pk_add_f32 v[26:27], v[26:27], v[118:119]
  v_pk_add_f32 v[40:41], v[40:41], v[120:121]
  v_pk_add_f32 v[42:43], v[42:43], v[122:123]
  v_pk_add_f32 v[72:73], v[72:73], v[124:125]
  v_pk_add_f32 v[74:75], v[74:75], v[126:127]
  v_pk_add_f32 v[88:89], v[88:89], v[128:129]
  v_pk_add_f32 v[90:91], v[90:91], v[130:131]
  v_pk_add_f32 v[184:185], v[184:185], v[132:133]
  v_pk_add_f32 v[186:187], v[186:187], v[134:135]
  s_waitcnt lgkmcnt(14)
  v_pk_add_f32 v[24:25], v[24:25], v[56:57]
  s_waitcnt lgkmcnt(12)
  v_pk_add_f32 v[60:61], v[60:61], v[64:65]
  v_pk_add_f32 v[26:27], v[26:27], v[58:59]
  v_pk_add_f32 v[62:63], v[62:63], v[66:67]
  v_pk_add_f32 v[24:25], v[24:25], v[60:61]
  v_pk_add_f32 v[26:27], v[26:27], v[62:63]
  v_cvt_pk_bf16_f32 v104, v24, v25
  v_cvt_pk_bf16_f32 v105, v26, v27
  s_waitcnt lgkmcnt(11)
  v_pk_add_f32 v[40:41], v[40:41], v[156:157]
  s_waitcnt lgkmcnt(9)
  v_pk_add_f32 v[160:161], v[160:161], v[164:165]
  v_pk_add_f32 v[42:43], v[42:43], v[158:159]
  v_pk_add_f32 v[162:163], v[162:163], v[166:167]
  v_pk_add_f32 v[40:41], v[40:41], v[160:161]
  v_pk_add_f32 v[42:43], v[42:43], v[162:163]
  v_cvt_pk_bf16_f32 v106, v40, v41
  v_cvt_pk_bf16_f32 v107, v42, v43
  s_waitcnt lgkmcnt(8)
  v_pk_add_f32 v[72:73], v[72:73], v[200:201]
  s_waitcnt lgkmcnt(6)
  v_pk_add_f32 v[204:205], v[204:205], v[208:209]
  v_pk_add_f32 v[74:75], v[74:75], v[202:203]
  v_pk_add_f32 v[206:207], v[206:207], v[210:211]
  v_pk_add_f32 v[72:73], v[72:73], v[204:205]
  v_pk_add_f32 v[74:75], v[74:75], v[206:207]
  v_cvt_pk_bf16_f32 v108, v72, v73
  v_cvt_pk_bf16_f32 v109, v74, v75
  s_waitcnt lgkmcnt(5)
  v_pk_add_f32 v[88:89], v[88:89], v[228:229]
  s_waitcnt lgkmcnt(3)
  v_pk_add_f32 v[232:233], v[232:233], v[236:237]
  v_pk_add_f32 v[90:91], v[90:91], v[230:231]
  v_pk_add_f32 v[234:235], v[234:235], v[238:239]
  v_pk_add_f32 v[88:89], v[88:89], v[232:233]
  v_pk_add_f32 v[90:91], v[90:91], v[234:235]
  v_cvt_pk_bf16_f32 v110, v88, v89
  v_cvt_pk_bf16_f32 v111, v90, v91
  s_waitcnt lgkmcnt(2)
  v_pk_add_f32 v[184:185], v[184:185], v[240:241]
  s_waitcnt lgkmcnt(0)
  v_pk_add_f32 v[244:245], v[244:245], v[248:249]
  v_pk_add_f32 v[186:187], v[186:187], v[242:243]
  v_pk_add_f32 v[246:247], v[246:247], v[250:251]
  v_pk_add_f32 v[184:185], v[184:185], v[244:245]
  v_pk_add_f32 v[186:187], v[186:187], v[246:247]
  v_cvt_pk_bf16_f32 v112, v184, v185
  v_cvt_pk_bf16_f32 v113, v186, v187
  buffer_store_dwordx4 v[104:107], v14, s[48:51], s31 offen
  buffer_store_dwordx4 v[108:111], v14, s[48:51], s31 offen offset:16
  buffer_store_dwordx2 v[112:113], v14, s[48:51], s31 offen offset:32
L2_end:
  s_endpgm
L2_fs:
  s_cmp_eq_u32 s39, 0
  s_cbranch_scc1 L2_fb
  s_sub_u32 s39, s39, 1
  buffer_load_dword v21, v22, s[20:23], s37 offen sc1
  s_waitcnt vmcnt(0)
  v_cmp_ne_u32 vcc, 0, v21
  s_nop 1
  s_cmp_eq_u64 vcc, -1
  s_cbranch_scc0 L2_fs
  s_branch L2_fb
L2_bs:
  s_cmp_eq_u32 s39, 0
  s_cbranch_scc1 L2_bb
  s_sub_u32 s39, s39, 1
  buffer_load_dword v255, v253, s[20:23], s73 offen sc1
  s_waitcnt vmcnt(0)
  v_cmp_eq_u32 vcc, 0, v255
  s_nop 1
  s_cbranch_vccnz L2_bs
  s_branch L2_bb
L2_st0:
  s_cmp_eq_u32 s39, 0
  s_cbranch_scc1 L2_bk0
  s_sub_u32 s39, s39, 1
  buffer_load_dwordx4 v[120:123], v16, s[44:47], s58 offen sc1
  buffer_load_dwordx4 v[124:127], v17, s[44:47], s58 offen sc1
  buffer_load_dwordx4 v[128:131], v18, s[44:47], s58 offen sc1
  buffer_load_dwordx4 v[132:135], v19, s[44:47], s58 offen sc1
  s_waitcnt vmcnt(0)
  v_max3_u32 v21, v120, v121, v122
  v_max3_u32 v21, v21, v123, v124
  v_max3_u32 v21, v21, v125, v126
  v_max3_u32 v21, v21, v127, v128
  v_max3_u32 v21, v21, v129, v130
  v_max3_u32 v21, v21, v131, v132
  v_max3_u32 v21, v21, v133, v134
  v_max_u32 v21, v21, v135
  v_cmp_eq_u32 vcc, -1, v21
  s_nop 1
  s_cbranch_vccnz L2_st0
  buffer_load_dwordx4 v[200:203], v16, s[44:47], s59 offen sc1
  buffer_load_dwordx4 v[204:207], v17, s[44:47], s59 offen sc1
  buffer_load_dwordx4 v[220:223], v18, s[44:47], s59 offen sc1
  buffer_load_dwordx4 v[224:227], v19, s[44:47], s59 offen sc1
  buffer_load_dwordx4 v[56:59], v16, s[44:47], s60 offen sc1
  buffer_load_dwordx4 v[60:63], v17, s[44:47], s60 offen sc1
  buffer_load_dwordx4 v[64:67], v18, s[44:47], s60 offen sc1
  s_branch L2_bk0
L2_st1:
  s_cmp_eq_u32 s39, 0
  s_cbranch_scc1 L2_bk1
  s_sub_u32 s39, s39, 1
  buffer_load_dwordx4 v[200:203], v16, s[44:47], s59 offen sc1
  buffer_load_dwordx4 v[204:207], v17, s[44:47], s59 offen sc1
  buffer_load_dwordx4 v[220:223], v18, s[44:47], s59 offen sc1
  buffer_load_dwordx4 v[224:227], v19, s[44:47], s59 offen sc1
  s_waitcnt vmcnt(0)
  v_max3_u32 v21, v200, v201, v202
  v_max3_u32 v21, v21, v203, v204
  v_max3_u32 v21, v21, v205, v206
  v_max3_u32 v21, v21, v207, v220
  v_max3_u32 v21, v21, v221, v222
  v_max3_u32 v21, v21, v223, v224
  v_max3_u32 v21, v21, v225, v226
  v_max_u32 v21, v21, v227
  v_cmp_eq_u32 vcc, -1, v21
  s_nop 1
  s_cbranch_vccnz L2_st1
  buffer_load_dwordx4 v[56:59], v16, s[44:47], s60 offen sc1
  buffer_load_dwordx4 v[60:63], v17, s[44:47], s60 offen sc1
  buffer_load_dwordx4 v[64:67], v18, s[44:47], s60 offen sc1
  buffer_load_dwordx4 v[68:71], v19, s[44:47], s60 offen sc1
  buffer_load_dwordx4 v[104:107], v16, s[44:47], s61 offen sc1
  buffer_load_dwordx4 v[108:111], v17, s[44:47], s61 offen sc1
  buffer_load_dwordx4 v[112:115], v18, s[44:47], s61 offen sc1
  buffer_load_dwordx4 v[116:119], v19, s[44:47], s61 offen sc1
  s_branch L2_bk1
L2_st2:
  s_cmp_eq_u32 s39, 0
  s_cbranch_scc1 L2_bk2
  s_sub_u32 s39, s39, 1
  buffer_load_dwordx4 v[56:59], v16, s[44:47], s60 offen sc1
  buffer_load_dwordx4 v[60:63], v17, s[44:47], s60 offen sc1
  buffer_load_dwordx4 v[64:67], v18, s[44:47], s60 offen sc1
  buffer_load_dwordx4 v[68:71], v19, s[44:47], s60 offen sc1
  s_waitcnt vmcnt(0)
  v_max3_u32 v21, v56, v57, v58
  v_max3_u32 v21, v21, v59, v60
  v_max3_u32 v21, v21, v61, v62
  v_max3_u32 v21, v21, v63, v64
  v_max3_u32 v21, v21, v65, v66
  v_max3_u32 v21, v21, v67, v68
  v_max3_u32 v21, v21, v69, v70
  v_max_u32 v21, v21, v71
  v_cmp_eq_u32 vcc, -1, v21
  s_nop 1
  s_cbranch_vccnz L2_st2
  buffer_load_dwordx4 v[104:107], v16, s[44:47], s61 offen sc1
  buffer_load_dwordx4 v[108:111], v17, s[44:47], s61 offen sc1
  buffer_load_dwordx4 v[112:115], v18, s[44:47], s61 offen sc1
  buffer_load_dwordx4 v[116:119], v19, s[44:47], s61 offen sc1
  buffer_load_dwordx4 v[156:159], v16, s[44:47], s62 offen sc1
  buffer_load_dwordx4 v[160:163], v17, s[44:47], s62 offen sc1
  buffer_load_dwordx4 v[164:167], v18, s[44:47], s62 offen sc1
  buffer_load_dwordx4 v[168:171], v19, s[44:47], s62 offen sc1
  buffer_load_dwordx4 v[172:175], v16, s[44:47], s63 offen sc1
  s_branch L2_bk2
L2_st3:
  s_cmp_eq_u32 s39, 0
  s_cbranch_scc1 L2_bk3
  s_sub_u32 s39, s39, 1
  buffer_load_dwordx4 v[104:107], v16, s[44:47], s61 offen sc1
  buffer_load_dwordx4 v[108:111], v17, s[44:47], s61 offen sc1
  buffer_load_dwordx4 v[112:115], v18, s[44:47], s61 offen sc1
  buffer_load_dwordx4 v[116:119], v19, s[44:47], s61 offen sc1
  s_waitcnt vmcnt(0)
  v_max3_u32 v21, v104, v105, v106
  v_max3_u32 v21, v21, v107, v108
  v_max3_u32 v21, v21, v109, v110
  v_max3_u32 v21, v21, v111, v112
  v_max3_u32 v21, v21, v113, v114
  v_max3_u32 v21, v21, v115, v116
  v_max3_u32 v21, v21, v117, v118
  v_max_u32 v21, v21, v119
  v_cmp_eq_u32 vcc, -1, v21
  s_nop 1
  s_cbranch_vccnz L2_st3
  buffer_load_dwordx4 v[156:159], v16, s[44:47], s62 offen sc1
  buffer_load_dwordx4 v[160:163], v17, s[44:47], s62 offen sc1
  buffer_load_dwordx4 v[164:167], v18, s[44:47], s62 offen sc1
  buffer_load_dwordx4 v[168:171], v19, s[44:47], s62 offen sc1
  buffer_load_dwordx4 v[172:175], v16, s[44:47], s63 offen sc1
  buffer_load_dwordx4 v[176:179], v17, s[44:47], s63 offen sc1
  buffer_load_dwordx4 v[180:183], v18, s[44:47], s63 offen sc1
  buffer_load_dwordx4 v[252:255], v19, s[44:47], s63 offen sc1
  buffer_load_dwordx4 v[244:247], v16, s[44:47], s64 offen sc1
  buffer_load_dwordx4 v[248:251], v17, s[44:47], s64 offen sc1
  s_branch L2_bk3
L2_st4:
  s_cmp_eq_u32 s39, 0
  s_cbranch_scc1 L2_bk4
  s_sub_u32 s39, s39, 1
  buffer_load_dwordx4 v[156:159], v16, s[44:47], s62 offen sc1
  buffer_load_dwordx4 v[160:163], v17, s[44:47], s62 offen sc1
  buffer_load_dwordx4 v[164:167], v18, s[44:47], s62 offen sc1
  buffer_load_dwordx4 v[168:171], v19, s[44:47], s62 offen sc1
  s_waitcnt vmcnt(0)
  v_max3_u32 v21, v156, v157, v158
  v_max3_u32 v21, v21, v159, v160
  v_max3_u32 v21, v21, v161, v162
  v_max3_u32 v21, v21, v163, v164
  v_max3_u32 v21, v21, v165, v166
  v_max3_u32 v21, v21, v167, v168
  v_max3_u32 v21, v21, v169, v170
  v_max_u32 v21, v21, v171
  v_cmp_eq_u32 vcc, -1, v21
  s_nop 1
  s_cbranch_vccnz L2_st4
  buffer_load_dwordx4 v[172:175], v16, s[44:47], s63 offen sc1
  buffer_load_dwordx4 v[176:179], v17, s[44:47], s63 offen sc1
  buffer_load_dwordx4 v[180:183], v18, s[44:47], s63 offen sc1
  buffer_load_dwordx4 v[252:255], v19, s[44:47], s63 offen sc1
  buffer_load_dwordx4 v[244:247], v16, s[44:47], s64 offen sc1
  buffer_load_dwordx4 v[248:251], v17, s[44:47], s64 offen sc1
  buffer_load_dwordx4 v[208:211], v18, s[44:47], s64 offen sc1
  buffer_load_dwordx4 v[212:215], v19, s[44:47], s64 offen sc1
  buffer_load_dwordx4 v[228:231], v16, s[44:47], s65 offen sc1
  buffer_load_dwordx4 v[232:235], v17, s[44:47], s65 offen sc1
  buffer_load_dwordx4 v[236:239], v18, s[44:47], s65 offen sc1
  s_branch L2_bk4
L2_st5:
  s_cmp_eq_u32 s39, 0
  s_cbranch_scc1 L2_bk5
  s_sub_u32 s39, s39, 1
  buffer_load_dwordx4 v[172:175], v16, s[44:47], s63 offen sc1
  buffer_load_dwordx4 v[176:179], v17, s[44:47], s63 offen sc1
  buffer_load_dwordx4 v[180:183], v18, s[44:47], s63 offen sc1
  buffer_load_dwordx4 v[252:255], v19, s[44:47], s63 offen sc1
  s_waitcnt vmcnt(0)
  v_max3_u32 v21, v172, v173, v174
  v_max3_u32 v21, v21, v175, v176
  v_max3_u32 v21, v21, v177, v178
  v_max3_u32 v21, v21, v179, v180
  v_max3_u32 v21, v21, v181, v182
  v_max3_u32 v21, v21, v183, v252
  v_max3_u32 v21, v21, v253, v254
  v_max_u32 v21, v21, v255
  v_cmp_eq_u32 vcc, -1, v21
  s_nop 1
  s_cbranch_vccnz L2_st5
  buffer_load_dwordx4 v[244:247], v16, s[44:47], s64 offen sc1
  buffer_load_dwordx4 v[248:251], v17, s[44:47], s64 offen sc1
  buffer_load_dwordx4 v[208:211], v18, s[44:47], s64 offen sc1
  buffer_load_dwordx4 v[212:215], v19, s[44:47], s64 offen sc1
  buffer_load_dwordx4 v[228:231], v16, s[44:47], s65 offen sc1
  buffer_load_dwordx4 v[232:235], v17, s[44:47], s65 offen sc1
  buffer_load_dwordx4 v[236:239], v18, s[44:47], s65 offen sc1
  buffer_load_dwordx4 v[240:243], v19, s[44:47], s65 offen sc1
  buffer_load_dwordx4 v[120:123], v16, s[44:47], s66 offen sc1
  buffer_load_dwordx4 v[124:127], v17, s[44:47], s66 offen sc1
  buffer_load_dwordx4 v[128:131], v18, s[44:47], s66 offen sc1
  buffer_load_dwordx4 v[132:135], v19, s[44:47], s66 offen sc1
  s_branch L2_bk5
L2_st6:
  s_cmp_eq_u32 s39, 0
  s_cbranch_scc1 L2_bk6
  s_sub_u32 s39, s39, 1
  buffer_load_dwordx4 v[244:247], v16, s[44:47], s64 offen sc1
  buffer_load_dwordx4 v[248:251], v17, s[44:47], s64 offen sc1
  buffer_load_dwordx4 v[208:211], v18, s[44:47], s64 offen sc1
  buffer_load_dwordx4 v[212:215], v19, s[44:47], s64 offen sc1
  s_waitcnt vmcnt(0)
  v_max3_u32 v21, v244, v245, v246
  v_max3_u32 v21, v21, v247, v248
  v_max3_u32 v21, v21, v249, v250
  v_max3_u32 v21, v21, v251, v208
  v_max3_u32 v21, v21, v209, v210
  v_max3_u32 v21, v21, v211, v212
  v_max3_u32 v21, v21, v213, v214
  v_max_u32 v21, v21, v215
  v_cmp_eq_u32 vcc, -1, v21
  s_nop 1
  s_cbranch_vccnz L2_st6
  buffer_load_dwordx4 v[228:231], v16, s[44:47], s65 offen sc1
  buffer_load_dwordx4 v[232:235], v17, s[44:47], s65 offen sc1
  buffer_load_dwordx4 v[236:239], v18, s[44:47], s65 offen sc1
  buffer_load_dwordx4 v[240:243], v19, s[44:47], s65 offen sc1
  buffer_load_dwordx4 v[120:123], v16, s[44:47], s66 offen sc1
  buffer_load_dwordx4 v[124:127], v17, s[44:47], s66 offen sc1
  buffer_load_dwordx4 v[128:131], v18, s[44:47], s66 offen sc1
  buffer_load_dwordx4 v[132:135], v19, s[44:47], s66 offen sc1
  buffer_load_dwordx4 v[200:203], v16, s[44:47], s67 offen sc1
  buffer_load_dwordx4 v[204:207], v17, s[44:47], s67 offen sc1
  buffer_load_dwordx4 v[220:223], v18, s[44:47], s67 offen sc1
  buffer_load_dwordx4 v[224:227], v19, s[44:47], s67 offen sc1
  buffer_load_dwordx4 v[56:59], v16, s[44:47], s68 offen sc1
  s_branch L2_bk6
L2_st7:
  s_cmp_eq_u32 s39, 0
  s_cbranch_scc1 L2_bk7
  s_sub_u32 s39, s39, 1
  buffer_load_dwordx4 v[228:231], v16, s[44:47], s65 offen sc1
  buffer_load_dwordx4 v[232:235], v17, s[44:47], s65 offen sc1
  buffer_load_dwordx4 v[236:239], v18, s[44:47], s65 offen sc1
  buffer_load_dwordx4 v[240:243], v19, s[44:47], s65 offen sc1
  s_waitcnt vmcnt(0)
  v_max3_u32 v21, v228, v229, v230
  v_max3_u32 v21, v21, v231, v232
  v_max3_u32 v21, v21, v233, v234
  v_max3_u32 v21, v21, v235, v236
  v_max3_u32 v21, v21, v237, v238
  v_max3_u32 v21, v21, v239, v240
  v_max3_u32 v21, v21, v241, v242
  v_max_u32 v21, v21, v243
  v_cmp_eq_u32 vcc, -1, v21
  s_nop 1
  s_cbranch_vccnz L2_st7
  buffer_load_dwordx4 v[120:123], v16, s[44:47], s66 offen sc1
  buffer_load_dwordx4 v[124:127], v17, s[44:47], s66 offen sc1
  buffer_load_dwordx4 v[128:131], v18, s[44:47], s66 offen sc1
  buffer_load_dwordx4 v[132:135], v19, s[44:47], s66 offen sc1
  buffer_load_dwordx4 v[200:203], v16, s[44:47], s67 offen sc1
  buffer_load_dwordx4 v[204:207], v17, s[44:47], s67 offen sc1
  buffer_load_dwordx4 v[220:223], v18, s[44:47], s67 offen sc1
  buffer_load_dwordx4 v[224:227], v19, s[44:47], s67 offen sc1
  buffer_load_dwordx4 v[56:59], v16, s[44:47], s68 offen sc1
  buffer_load_dwordx4 v[60:63], v17, s[44:47], s68 offen sc1
  buffer_load_dwordx4 v[64:67], v18, s[44:47], s68 offen sc1
  buffer_load_dwordx4 v[68:71], v19, s[44:47], s68 offen sc1
  buffer_load_dwordx4 v[104:107], v16, s[44:47], s69 offen sc1
  buffer_load_dwordx4 v[108:111], v17, s[44:47], s69 offen sc1
  s_branch L2_bk7
L2_st8:
  s_cmp_eq_u32 s39, 0
  s_cbranch_scc1 L2_bk8
  s_sub_u32 s39, s39, 1
  buffer_load_dwordx4 v[120:123], v16, s[44:47], s66 offen sc1
  buffer_load_dwordx4 v[124:127], v17, s[44:47], s66 offen sc1
  buffer_load_dwordx4 v[128:131], v18, s[44:47], s66 offen sc1
  buffer_load_dwordx4 v[132:135], v19, s[44:47], s66 offen sc1
  s_waitcnt vmcnt(0)
  v_max3_u32 v21, v120, v121, v122
  v_max3_u32 v21, v21, v123, v124
  v_max3_u32 v21, v21, v125, v126
  v_max3_u32 v21, v21, v127, v128
  v_max3_u32 v21, v21, v129, v130
  v_max3_u32 v21, v21, v131, v132
  v_max3_u32 v21, v21, v133, v134
  v_max_u32 v21, v21, v135
  v_cmp_eq_u32 vcc, -1, v21
  s_nop 1
  s_cbranch_vccnz L2_st8
  buffer_load_dwordx4 v[200:203], v16, s[44:47], s67 offen sc1
  buffer_load_dwordx4 v[204:207], v17, s[44:47], s67 offen sc1
  buffer_load_dwordx4 v[220:223], v18, s[44:47], s67 offen sc1
  buffer_load_dwordx4 v[224:227], v19, s[44:47], s67 offen sc1
  buffer_load_dwordx4 v[56:59], v16, s[44:47], s68 offen sc1
  buffer_load_dwordx4 v[60:63], v17, s[44:47], s68 offen sc1
  buffer_load_dwordx4 v[64:67], v18, s[44:47], s68 offen sc1
  buffer_load_dwordx4 v[68:71], v19, s[44:47], s68 offen sc1
  buffer_load_dwordx4 v[104:107], v16, s[44:47], s69 offen sc1
  buffer_load_dwordx4 v[108:111], v17, s[44:47], s69 offen sc1
  buffer_load_dwordx4 v[112:115], v18, s[44:47], s69 offen sc1
  buffer_load_dwordx4 v[116:119], v19, s[44:47], s69 offen sc1
  buffer_load_dwordx4 v[156:159], v16, s[44:47], s70 offen sc1
  buffer_load_dwordx4 v[160:163], v17, s[44:47], s70 offen sc1
  buffer_load_dwordx4 v[164:167], v18, s[44:47], s70 offen sc1
  s_branch L2_bk8
L2_st9:
  s_cmp_eq_u32 s39, 0
  s_cbranch_scc1 L2_bk9
  s_sub_u32 s39, s39, 1
  buffer_load_dwordx4 v[200:203], v16, s[44:47], s67 offen sc1
  buffer_load_dwordx4 v[204:207], v17, s[44:47], s67 offen sc1
  buffer_load_dwordx4 v[220:223], v18, s[44:47], s67 offen sc1
  buffer_load_dwordx4 v[224:227], v19, s[44:47], s67 offen sc1
  s_waitcnt vmcnt(0)
  v_max3_u32 v21, v200, v201, v202
  v_max3_u32 v21, v21, v203, v204
  v_max3_u32 v21, v21, v205, v206
  v_max3_u32 v21, v21, v207, v220
  v_max3_u32 v21, v21, v221, v222
  v_max3_u32 v21, v21, v223, v224
  v_max3_u32 v21, v21, v225, v226
  v_max_u32 v21, v21, v227
  v_cmp_eq_u32 vcc, -1, v21
  s_nop 1
  s_cbranch_vccnz L2_st9
  buffer_load_dwordx4 v[56:59], v16, s[44:47], s68 offen sc1
  buffer_load_dwordx4 v[60:63], v17, s[44:47], s68 offen sc1
  buffer_load_dwordx4 v[64:67], v18, s[44:47], s68 offen sc1
  buffer_load_dwordx4 v[68:71], v19, s[44:47], s68 offen sc1
  buffer_load_dwordx4 v[104:107], v16, s[44:47], s69 offen sc1
  buffer_load_dwordx4 v[108:111], v17, s[44:47], s69 offen sc1
  buffer_load_dwordx4 v[112:115], v18, s[44:47], s69 offen sc1
  buffer_load_dwordx4 v[116:119], v19, s[44:47], s69 offen sc1
  buffer_load_dwordx4 v[156:159], v16, s[44:47], s70 offen sc1
  buffer_load_dwordx4 v[160:163], v17, s[44:47], s70 offen sc1
  buffer_load_dwordx4 v[164:167], v18, s[44:47], s70 offen sc1
  buffer_load_dwordx4 v[168:171], v19, s[44:47], s70 offen sc1
  buffer_load_dwordx4 v[172:175], v16, s[44:47], s71 offen sc1
  buffer_load_dwordx4 v[176:179], v17, s[44:47], s71 offen sc1
  buffer_load_dwordx4 v[180:183], v18, s[44:47], s71 offen sc1
  buffer_load_dwordx4 v[252:255], v19, s[44:47], s71 offen sc1
  s_branch L2_bk9
L2_st10:
  s_cmp_eq_u32 s39, 0
  s_cbranch_scc1 L2_bk10
  s_sub_u32 s39, s39, 1
  buffer_load_dwordx4 v[56:59], v16, s[44:47], s68 offen sc1
  buffer_load_dwordx4 v[60:63], v17, s[44:47], s68 offen sc1
  buffer_load_dwordx4 v[64:67], v18, s[44:47], s68 offen sc1
  buffer_load_dwordx4 v[68:71], v19, s[44:47], s68 offen sc1
  s_waitcnt vmcnt(0)
  v_max3_u32 v21, v56, v57, v58
  v_max3_u32 v21, v21, v59, v60
  v_max3_u32 v21, v21, v61, v62
  v_max3_u32 v21, v21, v63, v64
  v_max3_u32 v21, v21, v65, v66
  v_max3_u32 v21, v21, v67, v68
  v_max3_u32 v21, v21, v69, v70
  v_max_u32 v21, v21, v71
  v_cmp_eq_u32 vcc, -1, v21
  s_nop 1
  s_cbranch_vccnz L2_st10
  buffer_load_dwordx4 v[104:107], v16, s[44:47], s69 offen sc1
  buffer_load_dwordx4 v[108:111], v17, s[44:47], s69 offen sc1
  buffer_load_dwordx4 v[112:115], v18, s[44:47], s69 offen sc1
  buffer_load_dwordx4 v[116:119], v19, s[44:47], s69 offen sc1
  buffer_load_dwordx4 v[156:159], v16, s[44:47], s70 offen sc1
  buffer_load_dwordx4 v[160:163], v17, s[44:47], s70 offen sc1
  buffer_load_dwordx4 v[164:167], v18, s[44:47], s70 offen sc1
  buffer_load_dwordx4 v[168:171], v19, s[44:47], s70 offen sc1
  buffer_load_dwordx4 v[172:175], v16, s[44:47], s71 offen sc1
  buffer_load_dwordx4 v[176:179], v17, s[44:47], s71 offen sc1
  buffer_load_dwordx4 v[180:183], v18, s[44:47], s71 offen sc1
  buffer_load_dwordx4 v[252:255], v19, s[44:47], s71 offen sc1
  s_branch L2_bk10
L2_st11:
  s_cmp_eq_u32 s39, 0
  s_cbranch_scc1 L2_bk11
  s_sub_u32 s39, s39, 1
  buffer_load_dwordx4 v[104:107], v16, s[44:47], s69 offen sc1
  buffer_load_dwordx4 v[108:111], v17, s[44:47], s69 offen sc1
  buffer_load_dwordx4 v[112:115], v18, s[44:47], s69 offen sc1
  buffer_load_dwordx4 v[116:119], v19, s[44:47], s69 offen sc1
  s_waitcnt vmcnt(0)
  v_max3_u32 v21, v104, v105, v106
  v_max3_u32 v21, v21, v107, v108
  v_max3_u32 v21, v21, v109, v110
  v_max3_u32 v21, v21, v111, v112
  v_max3_u32 v21, v21, v113, v114
  v_max3_u32 v21, v21, v115, v116
  v_max3_u32 v21, v21, v117, v118
  v_max_u32 v21, v21, v119
  v_cmp_eq_u32 vcc, -1, v21
  s_nop 1
  s_cbranch_vccnz L2_st11
  buffer_load_dwordx4 v[156:159], v16, s[44:47], s70 offen sc1
  buffer_load_dwordx4 v[160:163], v17, s[44:47], s70 offen sc1
  buffer_load_dwordx4 v[164:167], v18, s[44:47], s70 offen sc1
  buffer_load_dwordx4 v[168:171], v19, s[44:47], s70 offen sc1
  buffer_load_dwordx4 v[172:175], v16, s[44:47], s71 offen sc1
  buffer_load_dwordx4 v[176:179], v17, s[44:47], s71 offen sc1
  buffer_load_dwordx4 v[180:183], v18, s[44:47], s71 offen sc1
  buffer_load_dwordx4 v[252:255], v19, s[44:47], s71 offen sc1
  s_branch L2_bk11
L2_st12:
  s_cmp_eq_u32 s39, 0
  s_cbranch_scc1 L2_bk12
  s_sub_u32 s39, s39, 1
  buffer_load_dwordx4 v[156:159], v16, s[44:47], s70 offen sc1
  buffer_load_dwordx4 v[160:163], v17, s[44:47], s70 offen sc1
  buffer_load_dwordx4 v[164:167], v18, s[44:47], s70 offen sc1
  buffer_load_dwordx4 v[168:171], v19, s[44:47], s70 offen sc1
  s_waitcnt vmcnt(0)
  v_max3_u32 v21, v156, v157, v158
  v_max3_u32 v21, v21, v159, v160
  v_max3_u32 v21, v21, v161, v162
  v_max3_u32 v21, v21, v163, v164
  v_max3_u32 v21, v21, v165, v166
  v_max3_u32 v21, v21, v167, v168
  v_max3_u32 v21, v21, v169, v170
  v_max_u32 v21, v21, v171
  v_cmp_eq_u32 vcc, -1, v21
  s_nop 1
  s_cbranch_vccnz L2_st12
  buffer_load_dwordx4 v[172:175], v16, s[44:47], s71 offen sc1
  buffer_load_dwordx4 v[176:179], v17, s[44:47], s71 offen sc1
  buffer_load_dwordx4 v[180:183], v18, s[44:47], s71 offen sc1
  buffer_load_dwordx4 v[252:255], v19, s[44:47], s71 offen sc1
  s_branch L2_bk12
L2_st13:
  s_cmp_eq_u32 s39, 0
  s_cbranch_scc1 L2_bk13
  s_sub_u32 s39, s39, 1
  buffer_load_dwordx4 v[172:175], v16, s[44:47], s71 offen sc1
  buffer_load_dwordx4 v[176:179], v17, s[44:47], s71 offen sc1
  buffer_load_dwordx4 v[180:183], v18, s[44:47], s71 offen sc1
  buffer_load_dwordx4 v[252:255], v19, s[44:47], s71 offen sc1
  s_waitcnt vmcnt(0)
  v_max3_u32 v21, v172, v173, v174
  v_max3_u32 v21, v21, v175, v176
  v_max3_u32 v21, v21, v177, v178
  v_max3_u32 v21, v21, v179, v180
  v_max3_u32 v21, v21, v181, v182
  v_max3_u32 v21, v21, v183, v252
  v_max3_u32 v21, v21, v253, v254
  v_max_u32 v21, v21, v255
  v_cmp_eq_u32 vcc, -1, v21
  s_nop 1
  s_cbranch_vccnz L2_st13
  s_branch L2_bk13
Lcode_end:
.section .rodata,"a"
.p2align 6
.amdhsa_kernel sequential_preLN__ssm_conv_h3__swiglu_ffn__prompt_kernel
  .amdhsa_next_free_vgpr 512
  .amdhsa_next_free_sgpr 102
  .amdhsa_accum_offset 256
  .amdhsa_group_segment_fixed_size 0
  .amdhsa_kernarg_size 104
  .amdhsa_user_sgpr_count 2
  .amdhsa_user_sgpr_kernarg_segment_ptr 1
  .amdhsa_system_sgpr_workgroup_id_x 1
  .amdhsa_float_denorm_mode_32 3
.end_amdhsa_kernel
```
